```python
import torch

def _softmax(x, axis=-1):
    return torch.softmax(x, dim=axis)
def _gelu(x):
    return torch.nn.functional.gelu(x, approximate="tanh")
def _silu(x):
    return torch.nn.functional.silu(x)
def _sigmoid(x):
    return torch.sigmoid(x)
def _layernorm(x, axis=-1, eps=1e-5):
    m = x.mean(dim=axis, keepdim=True)
    v = x.var(dim=axis, keepdim=True, unbiased=False)
    return (x - m) / torch.sqrt(v + eps)
def _scatter_add(tgt, idx, src, axis=0):
    return tgt.clone().index_add_(axis, idx, src)
def _segment_sum(src, seg, n):
    out = torch.zeros((n,) + src.shape[1:], dtype=src.dtype)
    return out.index_add_(0, seg, src)
def _pad(x, pw):
    flat = tuple(v for pair in reversed(pw) for v in pair)
    return torch.nn.functional.pad(x, flat)

kernel_name = 'parallel_sum__softmax_full_mha__moe_arch_mod__prompt'

def setup_inputs():

    _w = (lambda a: (lambda t: t.to(torch.bfloat16) if t.is_floating_point() else t)(torch.as_tensor(a)))
    def _A_setup():
        B, S, D = 1, 2048, 640
        return {
            "x": _w((lambda *s: torch.randn(*s, dtype=torch.bfloat16) * 0.05)(B, S, D)),
            "wqkv": _w((lambda *s: torch.randn(*s, dtype=torch.bfloat16) * 0.1)(D, 3 * D)),
            "wo": _w((lambda *s: torch.randn(*s, dtype=torch.bfloat16) * 0.05)(D, D)),
        }
    _A_in = _A_setup()

    def _B_setup():
        B, S, D, F, C = 1, 2048, 640, 1728, 8
        return {
            "x": _w((lambda *s: torch.randn(*s, dtype=torch.bfloat16) * 0.05)(B, S, D)),
            "w_r": _w((lambda *s: torch.randn(*s, dtype=torch.bfloat16) * 1.6)(D)),
            "w_gate": _w((lambda *s: torch.randn(*s, dtype=torch.bfloat16) * 0.1)(D, F)),
            "w_up": _w((lambda *s: torch.randn(*s, dtype=torch.bfloat16) * 0.1)(D, F)),
            "w_down": _w((lambda *s: torch.randn(*s, dtype=torch.bfloat16) * 0.1)(F, D)),
        }
    _B_in = _B_setup()

    return {
        "A_x": _A_in["x"],
        "A_wqkv": _A_in["wqkv"],
        "A_wo": _A_in["wo"],
        "B_x": _B_in["x"],
        "B_w_r": _B_in["w_r"],
        "B_w_gate": _B_in["w_gate"],
        "B_w_up": _B_in["w_up"],
        "B_w_down": _B_in["w_down"],
    }

def reference(A_x, A_wqkv, A_wo, B_x, B_w_r, B_w_gate, B_w_up, B_w_down):
    def _A_ref(x, wqkv, wo):
        B, S, D = x.shape
        H = 32; Dh = D // H
        qkv = (lambda x, *d: x.permute(*d))((x @ wqkv).reshape(B, S, 3, H, Dh), 2, 0, 3, 1, 4)
        q, k, v = qkv[0], qkv[1], qkv[2]
        scale = Dh ** -0.5
        scores = torch.einsum("bhqd,bhkd->bhqk", q, k) * scale
        p = _softmax(scores, axis=-1)
        o = torch.einsum("bhqk,bhkd->bhqd", p, v)
        return (lambda x, *d: x.permute(*d))(o, 0, 2, 1, 3).reshape(B, S, D) @ wo

    def _B_ref(x, w_r, w_gate, w_up, w_down):
        B, S, D = x.shape
        C = 8
        r = x @ w_r
        idx = torch.argsort(-r, axis=-1)[:, :C]
        idx_e = (lambda x, n, axis: torch.repeat_interleave(x, n, dim=axis))(idx.reshape(B, C, 1), D, axis=2)
        x_sel = (lambda x, i, axis: torch.take_along_dim(x, i, dim=axis))(x, idx_e, axis=1)
        g = _silu(x_sel @ w_gate)
        u = x_sel @ w_up
        y = (g * u) @ w_down
        r_sel = _sigmoid((lambda x, i, axis: torch.take_along_dim(x, i, dim=axis))(r, idx, axis=1))
        y = y * r_sel.reshape(B, C, 1)
        b_off = (torch.arange(B) * S).reshape(B, 1)
        flat_idx = (idx + b_off).reshape(B * C)
        zero = (x * 0.0).reshape(B * S, D)
        upd = _scatter_add(zero, flat_idx, y.reshape(B * C, D), axis=0)
        return x + upd.reshape(B, S, D)

    x = A_x
    xn = _layernorm(x, axis=-1)
    return x + _A_ref(xn, A_wqkv, A_wo) + _B_ref(xn, B_w_r, B_w_gate, B_w_up, B_w_down)
```

```asm
; @launch grid=(256,1,1) block=(768,1,1) lds=160832
.amdgcn_target "amdgcn-amd-amdhsa--gfx950"
.text
.globl parallel_sum__softmax_full_mha__moe_arch_mod__prompt_kernel
.p2align 8
.type parallel_sum__softmax_full_mha__moe_arch_mod__prompt_kernel,@function
parallel_sum__softmax_full_mha__moe_arch_mod__prompt_kernel:
    s_cmp_ge_u32 s2, 256
    s_cbranch_scc1 k1_end
    s_load_dwordx4 s[4:7], s[0:1], 0
    s_load_dwordx2 s[8:9], s[0:1], 80
    v_lshrrev_b32 v1, 6, v0
    v_and_b32 v0, 63, v0
    v_readfirstlane_b32 s30, v1
    s_and_b32 s31, s2, 3
    s_lshl_b32 s31, s31, 2
    s_bfe_u32 s32, s2, 0x20003
    s_add_u32 s28, s31, s32
    s_bfe_u32 s31, s2, 0x10002
    s_lshl_b32 s31, s31, 3
    s_lshr_b32 s33, s2, 5
    s_xor_b32 s33, s33, 7
    s_add_u32 s29, s31, s33
    s_and_b32 s31, s30, 12
    s_cmp_eq_u32 s31, 4
    s_cbranch_scc1 k1_dist
    s_cmp_eq_u32 s29, 15
    s_cbranch_scc1 k1_aux
    s_cmp_lt_u32 s30, 4
    s_cbranch_scc1 k1_compute
    s_setprio 3
    s_mov_b32 s39, 0
    s_mov_b32 s34, 0
    s_sub_u32 s31, s30, 8
    v_lshrrev_b32 v1, 3, v0
    v_and_b32 v2, 7, v0
    v_lshrrev_b32 v3, 1, v1
    v_xor_b32 v2, v2, v3
    s_lshl_b32 s32, s28, 7
    s_lshl_b32 s38, s31, 5
    s_add_u32 s32, s32, s38
    v_add_u32 v1, s32, v1
    v_mul_u32_u24 v1, 1280, v1
    v_lshl_add_u32 v4, v2, 4, v1
    v_xor_b32 v5, 64, v4
    v_add_u32 v5, 9216, v5
    v_add_u32 v6, 18432, v4
    v_add_u32 v7, 18432, v5
    v_lshrrev_b32 v1, 4, v0
    v_and_b32 v2, 15, v0
    v_lshlrev_b32 v3, 2, v1
    v_xor_b32 v2, v2, v3
    s_lshl_b32 s38, s31, 4
    v_add_u32 v1, s38, v1
    v_mul_u32_u24 v1, 3840, v1
    v_lshl_add_u32 v1, v2, 4, v1
    s_lshl_b32 s38, s29, 8
    v_add_u32 v8, s38, v1
    v_add_u32 v9, 14336, v8
    v_add_u32 v10, 28672, v8
    v_add_u32 v11, 43008, v8
    s_lshl_b32 s35, s31, 12
    s_waitcnt lgkmcnt(0)
    s_mov_b32 s12, s4
    s_and_b32 s13, s5, 0xffff
    s_mov_b32 s14, 2621440
    s_mov_b32 s15, 0x00020000
    s_mov_b32 s16, s6
    s_and_b32 s17, s7, 0xffff
    s_mov_b32 s18, 2457600
    s_mov_b32 s19, 0x00020000
    s_mov_b32 m0, s35
    s_add_u32 s42, s35, 16384
    buffer_load_dwordx4 v4, s[12:15], s39 offen offset:0 lds
    buffer_load_dwordx4 v5, s[12:15], s39 offen offset:1024 lds
    buffer_load_dwordx4 v6, s[12:15], s39 offen offset:2048 lds
    buffer_load_dwordx4 v7, s[12:15], s39 offen offset:3072 lds
    s_mov_b32 m0, s42
    s_add_u32 s35, s35, 32768
    buffer_load_dwordx4 v8, s[16:19], s34 offen offset:0 lds
    buffer_load_dwordx4 v9, s[16:19], s34 offen offset:1024 lds
    buffer_load_dwordx4 v10, s[16:19], s34 offen offset:2048 lds
    buffer_load_dwordx4 v11, s[16:19], s34 offen offset:3072 lds
    s_add_u32 s39, s39, 128
    s_add_u32 s34, s34, 245760
    s_and_b32 s35, s35, 0x1ffff
    s_mov_b32 m0, s35
    s_add_u32 s42, s35, 16384
    buffer_load_dwordx4 v4, s[12:15], s39 offen offset:0 lds
    buffer_load_dwordx4 v5, s[12:15], s39 offen offset:1024 lds
    buffer_load_dwordx4 v6, s[12:15], s39 offen offset:2048 lds
    buffer_load_dwordx4 v7, s[12:15], s39 offen offset:3072 lds
    s_mov_b32 m0, s42
    s_add_u32 s35, s35, 32768
    buffer_load_dwordx4 v8, s[16:19], s34 offen offset:0 lds
    buffer_load_dwordx4 v9, s[16:19], s34 offen offset:1024 lds
    buffer_load_dwordx4 v10, s[16:19], s34 offen offset:2048 lds
    buffer_load_dwordx4 v11, s[16:19], s34 offen offset:3072 lds
    s_add_u32 s39, s39, 128
    s_add_u32 s34, s34, 245760
    s_and_b32 s35, s35, 0x1ffff
    s_load_dwordx4 s[44:47], s[0:1], 40
    s_load_dwordx2 s[48:49], s[0:1], 56
    s_load_dwordx2 s[50:51], s[0:1], 72
    s_waitcnt vmcnt(8)
    s_setprio 0
    s_barrier
    s_mov_b32 m0, s35
    s_add_u32 s42, s35, 16384
    buffer_load_dwordx4 v4, s[12:15], s39 offen offset:0 lds
    buffer_load_dwordx4 v5, s[12:15], s39 offen offset:1024 lds
    buffer_load_dwordx4 v6, s[12:15], s39 offen offset:2048 lds
    buffer_load_dwordx4 v7, s[12:15], s39 offen offset:3072 lds
    s_mov_b32 m0, s42
    s_add_u32 s35, s35, 32768
    buffer_load_dwordx4 v8, s[16:19], s34 offen offset:0 lds
    buffer_load_dwordx4 v9, s[16:19], s34 offen offset:1024 lds
    buffer_load_dwordx4 v10, s[16:19], s34 offen offset:2048 lds
    buffer_load_dwordx4 v11, s[16:19], s34 offen offset:3072 lds
    s_add_u32 s39, s39, 128
    s_add_u32 s34, s34, 245760
    s_and_b32 s35, s35, 0x1ffff
    s_mov_b32 m0, s35
    s_add_u32 s42, s35, 16384
    buffer_load_dwordx4 v4, s[12:15], s39 offen offset:0 lds
    buffer_load_dwordx4 v5, s[12:15], s39 offen offset:1024 lds
    buffer_load_dwordx4 v6, s[12:15], s39 offen offset:2048 lds
    buffer_load_dwordx4 v7, s[12:15], s39 offen offset:3072 lds
    s_waitcnt vmcnt(12)
    s_barrier
    s_mov_b32 m0, s42
    s_add_u32 s35, s35, 32768
    buffer_load_dwordx4 v8, s[16:19], s34 offen offset:0 lds
    buffer_load_dwordx4 v9, s[16:19], s34 offen offset:1024 lds
    buffer_load_dwordx4 v10, s[16:19], s34 offen offset:2048 lds
    buffer_load_dwordx4 v11, s[16:19], s34 offen offset:3072 lds
    s_add_u32 s39, s39, 128
    s_add_u32 s34, s34, 245760
    s_and_b32 s35, s35, 0x1ffff
    s_mov_b32 s37, 4
k1_ld_loop:
    s_mov_b32 m0, s35
    s_add_u32 s42, s35, 16384
    buffer_load_dwordx4 v4, s[12:15], s39 offen offset:0 lds
    buffer_load_dwordx4 v5, s[12:15], s39 offen offset:1024 lds
    buffer_load_dwordx4 v6, s[12:15], s39 offen offset:2048 lds
    buffer_load_dwordx4 v7, s[12:15], s39 offen offset:3072 lds
    s_mov_b32 m0, s42
    s_add_u32 s35, s35, 32768
    buffer_load_dwordx4 v8, s[16:19], s34 offen offset:0 lds
    buffer_load_dwordx4 v9, s[16:19], s34 offen offset:1024 lds
    buffer_load_dwordx4 v10, s[16:19], s34 offen offset:2048 lds
    buffer_load_dwordx4 v11, s[16:19], s34 offen offset:3072 lds
    s_add_u32 s39, s39, 128
    s_add_u32 s34, s34, 245760
    s_and_b32 s35, s35, 0x1ffff
    s_add_u32 s37, s37, 1
    s_waitcnt vmcnt(16)
    s_cmp_lt_u32 s37, 10
    s_barrier
    s_cbranch_scc1 k1_ld_loop
    s_waitcnt vmcnt(8)
    s_barrier
    s_waitcnt vmcnt(0)
    s_barrier
    s_mov_b64 exec, -1
    s_barrier
    s_cmp_lg_u32 s30, 8
    s_cbranch_scc1 k1_out
    s_waitcnt lgkmcnt(0)
    s_mov_b32 s24, s50
    s_and_b32 s25, s51, 0xffff
    s_mov_b32 s26, 256
    s_mov_b32 s27, 0x00020000
    s_mov_b32 s20, s8
    s_and_b32 s21, s9, 0xffff
    s_mov_b32 s22, 16777216
    s_mov_b32 s23, 0x00020000
    v_mov_b32 v1, 0
    s_mov_b32 s33, 0
k1_z0:
    buffer_load_dword v2, v1, s[24:27], 0 offen offset:4 sc1
    s_add_u32 s33, s33, 1
    s_waitcnt vmcnt(0)
    v_readfirstlane_b32 s34, v2
    s_cmp_gt_u32 s33, 0x4000
    s_cbranch_scc1 k1_z0_ok
    s_cmp_lg_u32 s34, 0
    s_cbranch_scc1 k1_z0_ok
    s_sleep 8
    s_branch k1_z0
k1_z0_ok:
k1_sig:
    s_barrier
    v_lshlrev_b32 v1, 7, v0
    v_mov_b32 v2, 1
    s_mul_i32 s31, s29, 2048
    s_add_u32 s31, s31, 12589056
    s_mov_b32 exec_lo, 0xffff
    s_mov_b32 exec_hi, 0
    buffer_atomic_add v2, v1, s[20:23], s31 offen sc1
    s_branch attn_kernel
k1_out:
    s_waitcnt vmcnt(0)
    s_barrier
    s_branch attn_kernel
k1_dist:
    s_setprio 3
    s_load_dwordx2 s[10:11], s[0:1], 32
    s_load_dwordx2 s[50:51], s[0:1], 72
    s_sub_u32 s33, s30, 4
    s_cmp_eq_u32 s29, 15
    s_cselect_b32 s37, 1, 0
    s_mov_b32 s36, 0x3f803f80
    s_mul_i32 s41, s28, 15
    s_add_u32 s41, s41, s29
    s_lshl_b32 s41, s41, 10
    s_add_u32 s42, s33, 2
    s_mul_i32 s43, s42, 245760
    s_add_u32 s41, s41, s43
    s_lshl_b32 s34, s28, 4
    s_add_u32 s34, s34, s29
    s_lshl_b32 s34, s34, 1
    s_add_u32 s34, s34, s33
    s_lshl_b32 s34, s34, 2
    v_lshlrev_b32 v60, 4, v0
    v_and_b32 v48, 0xf0, v60
    v_lshrrev_b32 v49, 4, v0
    v_add_u32 v53, s34, v49
    v_mul_u32_u24 v50, 1280, v53
    v_add_u32 v50, v50, v48
    v_mov_b64 v[44:45], 0
    v_mov_b64 v[46:47], 0
    v_mov_b32 v61, 0
    s_waitcnt lgkmcnt(0)
    s_mov_b32 s12, s4
    s_and_b32 s13, s5, 0xffff
    s_mov_b32 s14, 2621440
    s_mov_b32 s15, 0x00020000
    s_mov_b32 s16, s6
    s_and_b32 s17, s7, 0xffff
    s_mov_b32 s18, 2457600
    s_mov_b32 s19, 0x00020000
    s_mov_b32 s20, s8
    s_and_b32 s21, s9, 0xffff
    s_mov_b32 s22, 16777216
    s_mov_b32 s23, 0x00020000
    s_mov_b32 s24, s10
    s_and_b32 s25, s11, 0xffff
    s_mov_b32 s26, 1280
    s_mov_b32 s27, 0x00020000
    s_mov_b32 s44, s50
    s_and_b32 s45, s51, 0xffff
    s_mov_b32 s46, 256
    s_mov_b32 s47, 0x00020000
    s_cmp_ge_u32 s33, 2
    s_cbranch_scc1 k1_d_other
    buffer_load_dwordx4 v[4:7], v50, s[12:15], 0 offen offset:0
    buffer_load_dwordx4 v[8:11], v50, s[12:15], 0 offen offset:256
    buffer_load_dwordx4 v[12:15], v50, s[12:15], 0 offen offset:512
    buffer_load_dwordx4 v[16:19], v50, s[12:15], 0 offen offset:768
    buffer_load_dwordx4 v[20:23], v50, s[12:15], 0 offen offset:1024
    buffer_load_dwordx4 v[24:27], v48, s[24:27], 0 offen offset:0
    buffer_load_dwordx4 v[28:31], v48, s[24:27], 0 offen offset:256
    buffer_load_dwordx4 v[32:35], v48, s[24:27], 0 offen offset:512
    buffer_load_dwordx4 v[36:39], v48, s[24:27], 0 offen offset:768
    buffer_load_dwordx4 v[40:43], v48, s[24:27], 0 offen offset:1024
    s_cmp_eq_u32 s37, 1
    s_cbranch_scc1 k1_d_sum
    buffer_load_dwordx4 v[56:59], v60, s[16:19], s41 offen
    s_barrier
    s_add_u32 s41, s41, 983040
    buffer_load_dwordx4 v[56:59], v60, s[16:19], s41 offen
    s_barrier
    s_waitcnt vmcnt(2)
    s_branch k1_d_sum2
k1_d_sum:
    s_waitcnt vmcnt(0)
k1_d_sum2:
    v_dot2c_f32_bf16 v44, s36, v4
    v_dot2c_f32_bf16 v45, v4, v4
    v_dot2c_f32_bf16 v46, v4, v24
    v_dot2c_f32_bf16 v47, s36, v24
    v_dot2c_f32_bf16 v44, s36, v5
    v_dot2c_f32_bf16 v45, v5, v5
    v_dot2c_f32_bf16 v46, v5, v25
    v_dot2c_f32_bf16 v47, s36, v25
    v_dot2c_f32_bf16 v44, s36, v6
    v_dot2c_f32_bf16 v45, v6, v6
    v_dot2c_f32_bf16 v46, v6, v26
    v_dot2c_f32_bf16 v47, s36, v26
    v_dot2c_f32_bf16 v44, s36, v7
    v_dot2c_f32_bf16 v45, v7, v7
    v_dot2c_f32_bf16 v46, v7, v27
    v_dot2c_f32_bf16 v47, s36, v27
    v_dot2c_f32_bf16 v44, s36, v8
    v_dot2c_f32_bf16 v45, v8, v8
    v_dot2c_f32_bf16 v46, v8, v28
    v_dot2c_f32_bf16 v47, s36, v28
    v_dot2c_f32_bf16 v44, s36, v9
    v_dot2c_f32_bf16 v45, v9, v9
    v_dot2c_f32_bf16 v46, v9, v29
    v_dot2c_f32_bf16 v47, s36, v29
    v_dot2c_f32_bf16 v44, s36, v10
    v_dot2c_f32_bf16 v45, v10, v10
    v_dot2c_f32_bf16 v46, v10, v30
    v_dot2c_f32_bf16 v47, s36, v30
    v_dot2c_f32_bf16 v44, s36, v11
    v_dot2c_f32_bf16 v45, v11, v11
    v_dot2c_f32_bf16 v46, v11, v31
    v_dot2c_f32_bf16 v47, s36, v31
    v_dot2c_f32_bf16 v44, s36, v12
    v_dot2c_f32_bf16 v45, v12, v12
    v_dot2c_f32_bf16 v46, v12, v32
    v_dot2c_f32_bf16 v47, s36, v32
    v_dot2c_f32_bf16 v44, s36, v13
    v_dot2c_f32_bf16 v45, v13, v13
    v_dot2c_f32_bf16 v46, v13, v33
    v_dot2c_f32_bf16 v47, s36, v33
    v_dot2c_f32_bf16 v44, s36, v14
    v_dot2c_f32_bf16 v45, v14, v14
    v_dot2c_f32_bf16 v46, v14, v34
    v_dot2c_f32_bf16 v47, s36, v34
    v_dot2c_f32_bf16 v44, s36, v15
    v_dot2c_f32_bf16 v45, v15, v15
    v_dot2c_f32_bf16 v46, v15, v35
    v_dot2c_f32_bf16 v47, s36, v35
    v_dot2c_f32_bf16 v44, s36, v16
    v_dot2c_f32_bf16 v45, v16, v16
    v_dot2c_f32_bf16 v46, v16, v36
    v_dot2c_f32_bf16 v47, s36, v36
    v_dot2c_f32_bf16 v44, s36, v17
    v_dot2c_f32_bf16 v45, v17, v17
    v_dot2c_f32_bf16 v46, v17, v37
    v_dot2c_f32_bf16 v47, s36, v37
    v_dot2c_f32_bf16 v44, s36, v18
    v_dot2c_f32_bf16 v45, v18, v18
    v_dot2c_f32_bf16 v46, v18, v38
    v_dot2c_f32_bf16 v47, s36, v38
    v_dot2c_f32_bf16 v44, s36, v19
    v_dot2c_f32_bf16 v45, v19, v19
    v_dot2c_f32_bf16 v46, v19, v39
    v_dot2c_f32_bf16 v47, s36, v39
    v_dot2c_f32_bf16 v44, s36, v20
    v_dot2c_f32_bf16 v45, v20, v20
    v_dot2c_f32_bf16 v46, v20, v40
    v_dot2c_f32_bf16 v47, s36, v40
    v_dot2c_f32_bf16 v44, s36, v21
    v_dot2c_f32_bf16 v45, v21, v21
    v_dot2c_f32_bf16 v46, v21, v41
    v_dot2c_f32_bf16 v47, s36, v41
    v_dot2c_f32_bf16 v44, s36, v22
    v_dot2c_f32_bf16 v45, v22, v22
    v_dot2c_f32_bf16 v46, v22, v42
    v_dot2c_f32_bf16 v47, s36, v42
    v_dot2c_f32_bf16 v44, s36, v23
    v_dot2c_f32_bf16 v45, v23, v23
    v_dot2c_f32_bf16 v46, v23, v43
    v_dot2c_f32_bf16 v47, s36, v43
    s_nop 2
    v_add_f32_dpp v44, v44, v44 row_ror:8 row_mask:0xf bank_mask:0xf
    v_add_f32_dpp v45, v45, v45 row_ror:8 row_mask:0xf bank_mask:0xf
    v_add_f32_dpp v46, v46, v46 row_ror:8 row_mask:0xf bank_mask:0xf
    v_add_f32_dpp v47, v47, v47 row_ror:8 row_mask:0xf bank_mask:0xf
    v_add_f32_dpp v44, v44, v44 row_ror:4 row_mask:0xf bank_mask:0xf
    v_add_f32_dpp v45, v45, v45 row_ror:4 row_mask:0xf bank_mask:0xf
    v_add_f32_dpp v46, v46, v46 row_ror:4 row_mask:0xf bank_mask:0xf
    v_add_f32_dpp v47, v47, v47 row_ror:4 row_mask:0xf bank_mask:0xf
    v_add_f32_dpp v44, v44, v44 row_ror:2 row_mask:0xf bank_mask:0xf
    v_add_f32_dpp v45, v45, v45 row_ror:2 row_mask:0xf bank_mask:0xf
    v_add_f32_dpp v46, v46, v46 row_ror:2 row_mask:0xf bank_mask:0xf
    v_add_f32_dpp v47, v47, v47 row_ror:2 row_mask:0xf bank_mask:0xf
    v_add_f32_dpp v44, v44, v44 row_ror:1 row_mask:0xf bank_mask:0xf
    v_add_f32_dpp v45, v45, v45 row_ror:1 row_mask:0xf bank_mask:0xf
    v_add_f32_dpp v46, v46, v46 row_ror:1 row_mask:0xf bank_mask:0xf
    v_add_f32_dpp v47, v47, v47 row_ror:1 row_mask:0xf bank_mask:0xf
    v_mul_f32 v51, 0x3acccccd, v44
    v_mul_f32 v52, 0x3acccccd, v45
    v_fma_f32 v52, -v51, v51, v52
    v_max_f32 v52, 0, v52
    v_cvt_pk_bf16_f32 v54, v51, v51
    v_and_b32 v54, 0xffff0000, v54
    v_cvt_pk_bf16_f32 v52, v52, v52
    v_and_b32 v52, 0xffff0000, v52
    v_add_f32 v52, 0x3727c5ac, v52
    v_xor_b32 v54, 0x80000000, v54
    v_cvt_pk_bf16_f32 v52, v52, v52
    v_and_b32 v52, 0xffff0000, v52
    v_sqrt_f32 v52, v52
    s_nop 0
    v_cvt_pk_bf16_f32 v52, v52, v52
    v_and_b32 v52, 0xffff0000, v52
    v_rcp_f32 v55, v52
    s_nop 0
    v_fma_f32 v51, v54, v47, v46
    v_mul_f32 v51, v51, v55
    v_cvt_pk_bf16_f32 v51, v51, v51
    v_and_b32 v51, 0xffff0000, v51
    v_ashrrev_i32 v52, 31, v51
    v_or_b32 v52, 0x80000000, v52
    v_xor_b32 v51, v51, v52
    v_and_b32 v51, 0xffff0000, v51
    v_sub_u32 v52, 2047, v53
    v_or_b32 v51, v51, v52
    v_lshlrev_b32 v52, 3, v53
    v_lshlrev_b32 v53, 2, v53
    s_mov_b32 s31, 12546048
    s_mov_b32 s32, 12706816
    s_mov_b32 exec_lo, 0x00010001
    s_mov_b32 exec_hi, 0x00010001
    buffer_store_dwordx2 v[54:55], v52, s[20:23], s31 offen sc1
    buffer_store_dword v51, v53, s[20:23], s32 offen sc1
    s_mov_b64 exec, -1
    buffer_load_dword v62, v61, s[44:47], 0 offen offset:4 sc1
    s_cmp_eq_u32 s37, 1
    s_cbranch_scc1 k1_nb_1
    s_barrier
k1_nb_1:
    s_mov_b32 s35, 0
k1_d_z:
    s_waitcnt vmcnt(0)
    v_readfirstlane_b32 s38, v62
    s_add_u32 s35, s35, 1
    s_cmp_gt_u32 s35, 0x4000
    s_cbranch_scc1 k1_d_z_ok
    s_cmp_lg_u32 s38, 0
    s_cbranch_scc1 k1_d_z_ok
    s_sleep 8
    buffer_load_dword v62, v61, s[44:47], 0 offen offset:4 sc1
    s_branch k1_d_z
k1_d_z_ok:
    v_lshlrev_b32 v1, 7, v0
    v_mov_b32 v2, 1
    s_lshl_b32 s31, s28, 9
    s_add_u32 s31, s31, 12621824
    s_mov_b64 exec, 15
    buffer_atomic_add v2, v1, s[20:23], s31 offen sc1
    s_mov_b64 exec, -1
    s_cmp_eq_u32 s37, 1
    s_cbranch_scc1 k1_nb_2
    s_barrier
    s_barrier
    s_barrier
    s_barrier
    s_barrier
    s_barrier
    s_barrier
    s_barrier
k1_nb_2:
    s_branch k1_out
k1_d_other:
    s_cmp_eq_u32 s37, 1
    s_cbranch_scc1 k1_out
    buffer_load_dwordx4 v[56:59], v60, s[16:19], s41 offen
    s_barrier
    s_add_u32 s41, s41, 983040
    buffer_load_dwordx4 v[56:59], v60, s[16:19], s41 offen
    s_cmp_eq_u32 s33, 2
    s_cbranch_scc1 k1_d_fetch
    v_lshlrev_b32 v3, 21, v0
    s_mov_b64 exec, 0x7f
    buffer_load_dword v54, v3, s[20:23], 0 offen sc1
    s_mov_b64 exec, -1
    s_lshr_b32 s62, s2, 3
    s_lshl_b32 s63, s30, 8
    s_add_u32 s62, s62, s63
    s_cmp_lg_u32 s62, 1796
    s_cbranch_scc1 k1_nowarm
    s_load_dwordx2 s[62:63], s[0:1], 16
    s_load_dwordx4 s[44:47], s[0:1], 40
    s_load_dwordx4 s[48:51], s[0:1], 56
    s_load_dwordx2 s[56:57], s[0:1], 72
    s_getpc_b64 s[52:53]
k1_pc:
    s_add_u32 s52, s52, attn_kernel-k1_pc
    s_addc_u32 s53, s53, 0
    v_lshlrev_b32 v61, 7, v0
    v_min_u32 v3, k3_end-attn_kernel, v61
    v_add_u32 v61, 0x2000, v61
    global_load_dword v62, v3, s[52:53]
    v_min_u32 v3, k3_end-attn_kernel, v61
    v_add_u32 v61, 0x2000, v61
    global_load_dword v63, v3, s[52:53]
    v_min_u32 v3, k3_end-attn_kernel, v61
    v_add_u32 v61, 0x2000, v61
    global_load_dword v64, v3, s[52:53]
    v_lshlrev_b32 v3, 21, v0
    s_waitcnt lgkmcnt(0)
    s_mov_b64 exec, 1
    global_load_dword v54, v3, s[62:63]
    global_load_dword v54, v3, s[56:57] sc1
    s_mov_b64 exec, 3
    global_load_dword v54, v3, s[44:45]
    global_load_dword v54, v3, s[46:47]
    global_load_dword v54, v3, s[48:49]
    global_load_dword v54, v3, s[50:51]
    s_mov_b64 exec, -1
k1_nowarm:
    s_barrier
    s_barrier
    s_barrier
    s_barrier
    s_barrier
    s_barrier
    s_barrier
    s_barrier
    s_barrier
    s_barrier
    s_branch k1_out
k1_d_fetch:
    buffer_load_dword v62, v61, s[44:47], 0 offen offset:4 sc1
    s_lshl_b32 s31, s28, 2
    s_and_b32 s32, s29, 3
    s_add_u32 s31, s31, s32
    s_lshl_b32 s31, s31, 7
    s_add_u32 s31, s31, 12621824
    s_lshl_b32 s32, s28, 10
    s_add_u32 s32, s32, 12546048
    v_lshlrev_b32 v3, 3, v0
    v_add_u32 v3, 131072, v3
    s_barrier
    s_barrier
    s_barrier
    s_mov_b32 s35, 0
k1_f_z:
    s_waitcnt vmcnt(0)
    v_readfirstlane_b32 s38, v62
    s_add_u32 s35, s35, 1
    s_cmp_gt_u32 s35, 0x4000
    s_cbranch_scc1 k1_f_z_ok
    s_cmp_lg_u32 s38, 0
    s_cbranch_scc1 k1_f_z_ok
    s_sleep 8
    buffer_load_dword v62, v61, s[44:47], 0 offen offset:4 sc1
    s_branch k1_f_z
k1_f_z_ok:
    s_mov_b32 s39, 6
    s_mov_b32 s35, 0
    s_mov_b64 exec, 1
k1_f_poll:
    v_mov_b32 v62, 0
    buffer_atomic_add v62, v61, s[20:23], s31 offen sc0 sc1
    s_cmp_eq_u32 s39, 0
    s_cbranch_scc1 k1_f_nb
    s_barrier
    s_sub_u32 s39, s39, 1
k1_f_nb:
    s_add_u32 s35, s35, 1
    s_waitcnt vmcnt(0)
    v_readfirstlane_b32 s38, v62
    s_cmp_gt_u32 s35, 0x4000
    s_cbranch_scc1 k1_f_ok
    s_cmp_lg_u32 s38, 32
    s_cbranch_scc1 k1_f_poll
k1_f_ok:
    s_mov_b64 exec, -1
    buffer_load_dwordx4 v[4:7], v60, s[20:23], s32 offen sc1
k1_f_rest:
    s_cmp_eq_u32 s39, 0
    s_cbranch_scc1 k1_f_done
    s_barrier
    s_sub_u32 s39, s39, 1
    s_branch k1_f_rest
k1_f_done:
    s_waitcnt vmcnt(0)
    ds_write2_b32 v3, v4, v6 offset0:0 offset1:1
    ds_write2_b32 v3, v5, v7 offset0:128 offset1:129
    s_waitcnt lgkmcnt(0)
    s_barrier
    s_branch k1_out
k1_compute:
    s_setprio 2
    s_lshr_b32 s33, s30, 1
    s_and_b32 s34, s30, 1
    s_and_b32 s38, s30, 2
    s_lshl_b32 s39, s34, 1
    s_add_u32 s39, s39, s33
    v_and_b32 v154, 31, v0
    v_lshrrev_b32 v155, 5, v0
    v_bfe_u32 v156, v0, 1, 3
    v_xor_b32 v156, v156, v155
    s_lshl_b32 s31, s38, 5
    v_add_u32 v157, s31, v154
    v_lshlrev_b32 v157, 7, v157
    v_lshl_add_u32 v142, v156, 4, v157
    v_bfe_u32 v156, v0, 2, 2
    v_lshl_add_u32 v157, v155, 3, v156
    v_lshlrev_b32 v157, 8, v157
    v_xor_b32 v156, s39, v156
    v_lshl_add_u32 v157, v156, 6, v157
    v_bfe_u32 v156, v0, 4, 1
    v_lshl_add_u32 v157, v156, 5, v157
    v_and_b32 v156, 3, v0
    v_lshl_add_u32 v157, v156, 3, v157
    v_add_u32 v143, 16384, v157
    v_mov_b32 v132, 0x3f803f80
    v_mov_b32 v133, 0x3f803f80
    v_mov_b64 v[4:5], 0
    v_mov_b64 v[6:7], 0
    v_mov_b64 v[8:9], 0
    v_mov_b64 v[10:11], 0
    v_mov_b64 v[12:13], 0
    v_mov_b64 v[14:15], 0
    v_mov_b64 v[16:17], 0
    v_mov_b64 v[18:19], 0
    v_mov_b64 v[20:21], 0
    v_mov_b64 v[22:23], 0
    v_mov_b64 v[24:25], 0
    v_mov_b64 v[26:27], 0
    v_mov_b64 v[28:29], 0
    v_mov_b64 v[30:31], 0
    v_mov_b64 v[32:33], 0
    v_mov_b64 v[34:35], 0
    v_mov_b64 v[36:37], 0
    v_mov_b64 v[38:39], 0
    v_mov_b64 v[40:41], 0
    v_mov_b64 v[42:43], 0
    v_mov_b64 v[44:45], 0
    v_mov_b64 v[46:47], 0
    v_mov_b64 v[48:49], 0
    v_mov_b64 v[50:51], 0
    v_mov_b64 v[52:53], 0
    v_mov_b64 v[54:55], 0
    v_mov_b64 v[56:57], 0
    v_mov_b64 v[58:59], 0
    v_mov_b64 v[60:61], 0
    v_mov_b64 v[62:63], 0
    v_mov_b64 v[64:65], 0
    v_mov_b64 v[66:67], 0
    v_mov_b64 v[76:77], 0
    v_mov_b64 v[78:79], 0
    v_mov_b64 v[80:81], 0
    v_mov_b64 v[82:83], 0
    v_mov_b64 v[92:93], 0
    v_mov_b64 v[94:95], 0
    v_mov_b64 v[96:97], 0
    v_mov_b64 v[98:99], 0
    v_mov_b64 v[100:101], 0
    v_mov_b64 v[102:103], 0
    v_mov_b64 v[104:105], 0
    v_mov_b64 v[106:107], 0
    v_mov_b64 v[108:109], 0
    v_mov_b64 v[110:111], 0
    v_mov_b64 v[112:113], 0
    v_mov_b64 v[114:115], 0
    s_mov_b32 s35, 0
    s_waitcnt lgkmcnt(0)
    s_mov_b32 s20, s8
    s_and_b32 s21, s9, 0xffff
    s_mov_b32 s22, 16777216
    s_mov_b32 s23, 0x00020000
    s_cmp_ge_u32 s29, 10
    s_cbranch_scc1 k1_vpre
    s_cmp_lt_u32 s29, 5
    s_mov_b32 s40, 167936
    s_cmov_b32 s40, 81920
    s_mov_b32 s32, 5248
    s_cmov_b32 s32, 2560
    s_cselect_b32 s42, 0, 5
    s_cselect_b32 s55, 0, 2621440
    s_cselect_b32 s57, 0x3ea52b5c, 1.0
    s_sub_u32 s42, s29, s42
    s_lshl_b32 s42, s42, 4
    s_lshl_b32 s31, s28, 1
    s_add_u32 s31, s31, s33
    s_mul_i32 s31, s31, s32
    s_add_u32 s55, s55, s31
    v_bfe_u32 v156, v0, 2, 1
    v_xor_b32 v156, s39, v156
    v_and_b32 v157, 3, v0
    v_lshl_add_u32 v156, v156, 2, v157
    v_add_u32 v156, s42, v156
    v_mul_u32_u24 v157, 52429, v156
    v_lshrrev_b32 v157, 18, v157
    v_mul_u32_u24 v158, 5, v157
    v_sub_u32 v156, v156, v158
    v_cmp_le_u32 vcc, 3, v156
    v_cmp_eq_u32 s[58:59], 2, v156
    v_lshlrev_b32 v157, 1, v157
    v_subrev_u32 v158, 3, v156
    v_cndmask_b32 v156, v156, v158, vcc
    v_addc_co_u32 v157, vcc, 0, v157, vcc
    v_cndmask_b32 v156, v156, 0, s[58:59]
    v_mul_u32_u24 v157, s40, v157
    v_lshl_add_u32 v156, v156, 9, v157
    v_add_u32 v70, s55, v156
    v_mov_b32 v158, 0x40000000
    v_cndmask_b32 v68, v70, v158, s[58:59]
    s_and_b32 s61, s58, 0xff
    v_cmp_gt_u32 vcc, 32, v0
    v_lshlrev_b32 v159, 4, v154
    v_mad_u32_u24 v160, v155, s40, v159
    s_bitcmp1_b32 s61, 1
    s_cselect_b32 m0, 1, 0
    v_readlane_b32 s51, v68, 0
    v_readlane_b32 s52, v68, 1
    v_readlane_b32 s60, v70, m0
    v_mov_b32 v156, s51
    v_mov_b32 v157, s52
    v_add_u32 v120, s60, v160
    v_cndmask_b32 v156, v157, v156, vcc
    v_add_u32 v116, v156, v159
    s_bitcmp1_b32 s61, 3
    s_cselect_b32 m0, 3, 2
    v_readlane_b32 s51, v68, 2
    v_readlane_b32 s52, v68, 3
    v_readlane_b32 s60, v70, m0
    v_mov_b32 v156, s51
    v_mov_b32 v157, s52
    v_add_u32 v121, s60, v160
    v_cndmask_b32 v156, v157, v156, vcc
    v_add_u32 v117, v156, v159
    s_bitcmp1_b32 s61, 5
    s_cselect_b32 m0, 5, 4
    v_readlane_b32 s51, v68, 4
    v_readlane_b32 s52, v68, 5
    v_readlane_b32 s60, v70, m0
    v_mov_b32 v156, s51
    v_mov_b32 v157, s52
    v_add_u32 v122, s60, v160
    v_cndmask_b32 v156, v157, v156, vcc
    v_add_u32 v118, v156, v159
    s_bitcmp1_b32 s61, 7
    s_cselect_b32 m0, 7, 6
    v_readlane_b32 s51, v68, 6
    v_readlane_b32 s52, v68, 7
    v_readlane_b32 s60, v70, m0
    v_mov_b32 v156, s51
    v_mov_b32 v157, s52
    v_add_u32 v123, s60, v160
    v_cndmask_b32 v156, v157, v156, vcc
    v_add_u32 v119, v156, v159
    s_mov_b32 s37, 0
    v_add_u32 v144, s35, v142
    v_add_u32 v152, s35, v143
    v_xor_b32 v148, 4096, v144
    v_xor_b32 v153, 64, v152
k1_qkloop:
    s_waitcnt lgkmcnt(0)
    v_mfma_f32_32x32x16_bf16 v[4:19], v[92:95], v[76:79], v[4:19]
    s_barrier
    ds_read_b128 v[68:71], v144
    ds_read_b64_tr_b16 v[84:85], v152 offset:0
    v_xor_b32 v145, 32, v144
    v_xor_b32 v149, 32, v148
    v_mfma_f32_32x32x16_bf16 v[52:67], v[96:99], v[80:83], v[52:67]
    ds_read_b64_tr_b16 v[86:87], v152 offset:1024
    ds_read_b128 v[72:75], v148
    v_xor_b32 v146, 64, v144
    v_xor_b32 v150, 64, v148
    v_mfma_f32_32x32x16_bf16 v[20:35], v[96:99], v[76:79], v[20:35]
    ds_read_b64_tr_b16 v[88:89], v153 offset:0
    ds_read_b64_tr_b16 v[90:91], v153 offset:1024
    v_xor_b32 v147, 96, v144
    v_xor_b32 v151, 96, v148
    v_mfma_f32_32x32x16_bf16 v[36:51], v[92:95], v[80:83], v[36:51]
    v_mfma_f32_4x4x4bf16_1k v[100:103], v[132:133], v[92:93], v[100:103]
    v_mfma_f32_4x4x4bf16_1k v[104:107], v[132:133], v[94:95], v[104:107]
    s_waitcnt lgkmcnt(3)
    v_mfma_f32_4x4x4bf16_1k v[108:111], v[132:133], v[84:85], v[108:111]
    v_mfma_f32_4x4x4bf16_1k v[112:115], v[132:133], v[86:87], v[112:115]
    v_mfma_f32_32x32x16_bf16 v[4:19], v[84:87], v[68:71], v[4:19]
    ds_read_b128 v[76:79], v145
    ds_read_b64_tr_b16 v[92:93], v152 offset:4096
    s_add_u32 s35, s35, 32768
    s_waitcnt lgkmcnt(2)
    v_mfma_f32_32x32x16_bf16 v[52:67], v[88:91], v[72:75], v[52:67]
    ds_read_b64_tr_b16 v[94:95], v152 offset:5120
    ds_read_b128 v[80:83], v149
    s_and_b32 s35, s35, 0x1ffff
    v_mfma_f32_32x32x16_bf16 v[20:35], v[88:91], v[68:71], v[20:35]
    ds_read_b64_tr_b16 v[96:97], v153 offset:4096
    ds_read_b64_tr_b16 v[98:99], v153 offset:5120
    v_mfma_f32_32x32x16_bf16 v[36:51], v[84:87], v[72:75], v[36:51]
    s_waitcnt lgkmcnt(3)
    v_mfma_f32_32x32x16_bf16 v[4:19], v[92:95], v[76:79], v[4:19]
    ds_read_b128 v[68:71], v146
    ds_read_b64_tr_b16 v[84:85], v152 offset:8192
    s_waitcnt lgkmcnt(2)
    v_mfma_f32_32x32x16_bf16 v[52:67], v[96:99], v[80:83], v[52:67]
    ds_read_b64_tr_b16 v[86:87], v152 offset:9216
    ds_read_b128 v[72:75], v150
    v_mfma_f32_32x32x16_bf16 v[20:35], v[96:99], v[76:79], v[20:35]
    ds_read_b64_tr_b16 v[88:89], v153 offset:8192
    ds_read_b64_tr_b16 v[90:91], v153 offset:9216
    v_mfma_f32_32x32x16_bf16 v[36:51], v[92:95], v[80:83], v[36:51]
    v_mfma_f32_4x4x4bf16_1k v[100:103], v[132:133], v[92:93], v[100:103]
    v_mfma_f32_4x4x4bf16_1k v[104:107], v[132:133], v[94:95], v[104:107]
    s_waitcnt lgkmcnt(3)
    v_mfma_f32_4x4x4bf16_1k v[108:111], v[132:133], v[84:85], v[108:111]
    v_mfma_f32_4x4x4bf16_1k v[112:115], v[132:133], v[86:87], v[112:115]
    v_mfma_f32_32x32x16_bf16 v[4:19], v[84:87], v[68:71], v[4:19]
    ds_read_b128 v[76:79], v147
    ds_read_b64_tr_b16 v[92:93], v152 offset:12288
    ds_read_b64_tr_b16 v[94:95], v152 offset:13312
    s_add_u32 s37, s37, 1
    s_waitcnt lgkmcnt(3)
    v_mfma_f32_32x32x16_bf16 v[52:67], v[88:91], v[72:75], v[52:67]
    ds_read_b128 v[80:83], v151
    ds_read_b64_tr_b16 v[96:97], v153 offset:12288
    ds_read_b64_tr_b16 v[98:99], v153 offset:13312
    s_cmp_lt_u32 s37, 10
    v_mfma_f32_32x32x16_bf16 v[20:35], v[88:91], v[68:71], v[20:35]
    v_mfma_f32_32x32x16_bf16 v[36:51], v[84:87], v[72:75], v[36:51]
    v_add_u32 v144, s35, v142
    v_add_u32 v152, s35, v143
    v_xor_b32 v148, 4096, v144
    v_xor_b32 v153, 64, v152
    s_cbranch_scc1 k1_qkloop
    s_waitcnt lgkmcnt(0)
    v_mfma_f32_32x32x16_bf16 v[4:19], v[92:95], v[76:79], v[4:19]
    v_mfma_f32_32x32x16_bf16 v[52:67], v[96:99], v[80:83], v[52:67]
    v_mfma_f32_32x32x16_bf16 v[20:35], v[96:99], v[76:79], v[20:35]
    v_mfma_f32_32x32x16_bf16 v[36:51], v[92:95], v[80:83], v[36:51]
    v_mfma_f32_4x4x4bf16_1k v[100:103], v[132:133], v[92:93], v[100:103]
    v_mfma_f32_4x4x4bf16_1k v[104:107], v[132:133], v[94:95], v[104:107]
    s_lshl_b32 s31, s39, 7
    s_add_u32 s31, s31, 132096
    v_lshl_add_u32 v157, v154, 2, s31
    v_add_f32 v108, v108, v112
    s_nop 0
    v_add_f32 v100, v100, v104
    v_add_f32 v100, v100, v108
    v_mov_b32 v158, v100
    s_nop 1
    v_permlane32_swap_b32 v100, v158
    s_nop 0
    v_add_f32 v100, v100, v158
    ds_write_b32 v157, v100
    s_waitcnt lgkmcnt(0)
    s_barrier
    s_lshl_b32 s31, s38, 7
    s_add_u32 s31, s31, 131072
    v_lshl_add_u32 v156, v154, 2, s31
    v_xor_b32 v159, 128, v156
    s_lshl_b32 s31, s39, 7
    s_add_u32 s31, s31, 132096
    v_lshl_add_u32 v157, v155, 4, s31
    v_xor_b32 v158, 128, v157
    ds_read2_b32 v[134:135], v156 offset0:0 offset1:128
    ds_read_b128 v[68:71], v157
    ds_read2_b32 v[136:137], v159 offset0:0 offset1:128
    ds_read_b128 v[72:75], v157 offset:32
    ds_read_b128 v[76:79], v157 offset:64
    ds_read_b128 v[80:83], v157 offset:96
    ds_read_b128 v[84:87], v158 offset:0
    ds_read_b128 v[88:91], v158 offset:32
    ds_read_b128 v[92:95], v158 offset:64
    ds_read_b128 v[96:99], v158 offset:96
    s_waitcnt lgkmcnt(8)
    v_mul_f32 v135, s57, v135
    v_pk_fma_f32 v[4:5], v[68:69], v[134:135], v[4:5] op_sel:[0,0,0] op_sel_hi:[1,0,1]
    v_pk_fma_f32 v[6:7], v[70:71], v[134:135], v[6:7] op_sel:[0,0,0] op_sel_hi:[1,0,1]
    v_pk_mul_f32 v[4:5], v[4:5], v[134:135] op_sel:[0,1] op_sel_hi:[1,1]
    v_pk_mul_f32 v[6:7], v[6:7], v[134:135] op_sel:[0,1] op_sel_hi:[1,1]
    v_cvt_pk_bf16_f32 v100, v4, v5
    v_cvt_pk_bf16_f32 v101, v6, v7
    s_waitcnt lgkmcnt(6)
    v_pk_fma_f32 v[8:9], v[72:73], v[134:135], v[8:9] op_sel:[0,0,0] op_sel_hi:[1,0,1]
    v_pk_fma_f32 v[10:11], v[74:75], v[134:135], v[10:11] op_sel:[0,0,0] op_sel_hi:[1,0,1]
    v_pk_mul_f32 v[8:9], v[8:9], v[134:135] op_sel:[0,1] op_sel_hi:[1,1]
    v_pk_mul_f32 v[10:11], v[10:11], v[134:135] op_sel:[0,1] op_sel_hi:[1,1]
    v_cvt_pk_bf16_f32 v102, v8, v9
    v_cvt_pk_bf16_f32 v103, v10, v11
    s_waitcnt lgkmcnt(7)
    v_mul_f32 v137, s57, v137
    v_pk_fma_f32 v[36:37], v[68:69], v[136:137], v[36:37] op_sel:[0,0,0] op_sel_hi:[1,0,1]
    v_pk_fma_f32 v[38:39], v[70:71], v[136:137], v[38:39] op_sel:[0,0,0] op_sel_hi:[1,0,1]
    v_pk_mul_f32 v[36:37], v[36:37], v[136:137] op_sel:[0,1] op_sel_hi:[1,1]
    v_pk_mul_f32 v[38:39], v[38:39], v[136:137] op_sel:[0,1] op_sel_hi:[1,1]
    v_cvt_pk_bf16_f32 v104, v36, v37
    v_cvt_pk_bf16_f32 v105, v38, v39
    v_pk_fma_f32 v[40:41], v[72:73], v[136:137], v[40:41] op_sel:[0,0,0] op_sel_hi:[1,0,1]
    v_pk_fma_f32 v[42:43], v[74:75], v[136:137], v[42:43] op_sel:[0,0,0] op_sel_hi:[1,0,1]
    v_pk_mul_f32 v[40:41], v[40:41], v[136:137] op_sel:[0,1] op_sel_hi:[1,1]
    v_pk_mul_f32 v[42:43], v[42:43], v[136:137] op_sel:[0,1] op_sel_hi:[1,1]
    v_cvt_pk_bf16_f32 v106, v40, v41
    v_cvt_pk_bf16_f32 v107, v42, v43
    s_bitcmp1_b32 s61, 0
    s_cbranch_scc0 k1_sp_3
    v_mov_b64 v[144:145], v[100:101]
    v_mov_b64 v[146:147], v[104:105]
    buffer_store_dwordx4 v[144:147], v120, s[20:23], 0 offen offset:2048 sc1
k1_sp_3:
    s_bitcmp1_b32 s61, 1
    s_cbranch_scc0 k1_sp_4
    v_mov_b64 v[144:145], v[102:103]
    v_mov_b64 v[146:147], v[106:107]
    buffer_store_dwordx4 v[144:147], v120, s[20:23], 0 offen offset:2048 sc1
k1_sp_4:
    v_permlane32_swap_b32 v100, v102
    v_permlane32_swap_b32 v101, v103
    buffer_store_dwordx4 v[100:103], v116, s[20:23], 0 offen offset:0 sc1
    v_permlane32_swap_b32 v104, v106
    v_permlane32_swap_b32 v105, v107
    buffer_store_dwordx4 v[104:107], v116, s[20:23], 0 offen offset:1024 sc1
    s_waitcnt lgkmcnt(5)
    v_pk_fma_f32 v[12:13], v[76:77], v[134:135], v[12:13] op_sel:[0,0,0] op_sel_hi:[1,0,1]
    v_pk_fma_f32 v[14:15], v[78:79], v[134:135], v[14:15] op_sel:[0,0,0] op_sel_hi:[1,0,1]
    v_pk_mul_f32 v[12:13], v[12:13], v[134:135] op_sel:[0,1] op_sel_hi:[1,1]
    v_pk_mul_f32 v[14:15], v[14:15], v[134:135] op_sel:[0,1] op_sel_hi:[1,1]
    v_cvt_pk_bf16_f32 v124, v12, v13
    v_cvt_pk_bf16_f32 v125, v14, v15
    s_waitcnt lgkmcnt(4)
    v_pk_fma_f32 v[16:17], v[80:81], v[134:135], v[16:17] op_sel:[0,0,0] op_sel_hi:[1,0,1]
    v_pk_fma_f32 v[18:19], v[82:83], v[134:135], v[18:19] op_sel:[0,0,0] op_sel_hi:[1,0,1]
    v_pk_mul_f32 v[16:17], v[16:17], v[134:135] op_sel:[0,1] op_sel_hi:[1,1]
    v_pk_mul_f32 v[18:19], v[18:19], v[134:135] op_sel:[0,1] op_sel_hi:[1,1]
    v_cvt_pk_bf16_f32 v126, v16, v17
    v_cvt_pk_bf16_f32 v127, v18, v19
    v_pk_fma_f32 v[44:45], v[76:77], v[136:137], v[44:45] op_sel:[0,0,0] op_sel_hi:[1,0,1]
    v_pk_fma_f32 v[46:47], v[78:79], v[136:137], v[46:47] op_sel:[0,0,0] op_sel_hi:[1,0,1]
    v_pk_mul_f32 v[44:45], v[44:45], v[136:137] op_sel:[0,1] op_sel_hi:[1,1]
    v_pk_mul_f32 v[46:47], v[46:47], v[136:137] op_sel:[0,1] op_sel_hi:[1,1]
    v_cvt_pk_bf16_f32 v128, v44, v45
    v_cvt_pk_bf16_f32 v129, v46, v47
    v_pk_fma_f32 v[48:49], v[80:81], v[136:137], v[48:49] op_sel:[0,0,0] op_sel_hi:[1,0,1]
    v_pk_fma_f32 v[50:51], v[82:83], v[136:137], v[50:51] op_sel:[0,0,0] op_sel_hi:[1,0,1]
    v_pk_mul_f32 v[48:49], v[48:49], v[136:137] op_sel:[0,1] op_sel_hi:[1,1]
    v_pk_mul_f32 v[50:51], v[50:51], v[136:137] op_sel:[0,1] op_sel_hi:[1,1]
    v_cvt_pk_bf16_f32 v130, v48, v49
    v_cvt_pk_bf16_f32 v131, v50, v51
    s_bitcmp1_b32 s61, 2
    s_cbranch_scc0 k1_sp_5
    v_mov_b64 v[144:145], v[124:125]
    v_mov_b64 v[146:147], v[128:129]
    buffer_store_dwordx4 v[144:147], v121, s[20:23], 0 offen offset:2048 sc1
k1_sp_5:
    s_bitcmp1_b32 s61, 3
    s_cbranch_scc0 k1_sp_6
    v_mov_b64 v[144:145], v[126:127]
    v_mov_b64 v[146:147], v[130:131]
    buffer_store_dwordx4 v[144:147], v121, s[20:23], 0 offen offset:2048 sc1
k1_sp_6:
    v_permlane32_swap_b32 v124, v126
    v_permlane32_swap_b32 v125, v127
    buffer_store_dwordx4 v[124:127], v117, s[20:23], 0 offen offset:0 sc1
    v_permlane32_swap_b32 v128, v130
    v_permlane32_swap_b32 v129, v131
    buffer_store_dwordx4 v[128:131], v117, s[20:23], 0 offen offset:1024 sc1
    s_waitcnt lgkmcnt(3)
    v_pk_fma_f32 v[20:21], v[84:85], v[134:135], v[20:21] op_sel:[0,0,0] op_sel_hi:[1,0,1]
    v_pk_fma_f32 v[22:23], v[86:87], v[134:135], v[22:23] op_sel:[0,0,0] op_sel_hi:[1,0,1]
    v_pk_mul_f32 v[20:21], v[20:21], v[134:135] op_sel:[0,1] op_sel_hi:[1,1]
    v_pk_mul_f32 v[22:23], v[22:23], v[134:135] op_sel:[0,1] op_sel_hi:[1,1]
    v_cvt_pk_bf16_f32 v100, v20, v21
    v_cvt_pk_bf16_f32 v101, v22, v23
    s_waitcnt lgkmcnt(2)
    v_pk_fma_f32 v[24:25], v[88:89], v[134:135], v[24:25] op_sel:[0,0,0] op_sel_hi:[1,0,1]
    v_pk_fma_f32 v[26:27], v[90:91], v[134:135], v[26:27] op_sel:[0,0,0] op_sel_hi:[1,0,1]
    v_pk_mul_f32 v[24:25], v[24:25], v[134:135] op_sel:[0,1] op_sel_hi:[1,1]
    v_pk_mul_f32 v[26:27], v[26:27], v[134:135] op_sel:[0,1] op_sel_hi:[1,1]
    v_cvt_pk_bf16_f32 v102, v24, v25
    v_cvt_pk_bf16_f32 v103, v26, v27
    v_pk_fma_f32 v[52:53], v[84:85], v[136:137], v[52:53] op_sel:[0,0,0] op_sel_hi:[1,0,1]
    v_pk_fma_f32 v[54:55], v[86:87], v[136:137], v[54:55] op_sel:[0,0,0] op_sel_hi:[1,0,1]
    v_pk_mul_f32 v[52:53], v[52:53], v[136:137] op_sel:[0,1] op_sel_hi:[1,1]
    v_pk_mul_f32 v[54:55], v[54:55], v[136:137] op_sel:[0,1] op_sel_hi:[1,1]
    v_cvt_pk_bf16_f32 v104, v52, v53
    v_cvt_pk_bf16_f32 v105, v54, v55
    v_pk_fma_f32 v[56:57], v[88:89], v[136:137], v[56:57] op_sel:[0,0,0] op_sel_hi:[1,0,1]
    v_pk_fma_f32 v[58:59], v[90:91], v[136:137], v[58:59] op_sel:[0,0,0] op_sel_hi:[1,0,1]
    v_pk_mul_f32 v[56:57], v[56:57], v[136:137] op_sel:[0,1] op_sel_hi:[1,1]
    v_pk_mul_f32 v[58:59], v[58:59], v[136:137] op_sel:[0,1] op_sel_hi:[1,1]
    v_cvt_pk_bf16_f32 v106, v56, v57
    v_cvt_pk_bf16_f32 v107, v58, v59
    s_bitcmp1_b32 s61, 4
    s_cbranch_scc0 k1_sp_7
    v_mov_b64 v[144:145], v[100:101]
    v_mov_b64 v[146:147], v[104:105]
    buffer_store_dwordx4 v[144:147], v122, s[20:23], 0 offen offset:2048 sc1
k1_sp_7:
    s_bitcmp1_b32 s61, 5
    s_cbranch_scc0 k1_sp_8
    v_mov_b64 v[144:145], v[102:103]
    v_mov_b64 v[146:147], v[106:107]
    buffer_store_dwordx4 v[144:147], v122, s[20:23], 0 offen offset:2048 sc1
k1_sp_8:
    v_permlane32_swap_b32 v100, v102
    v_permlane32_swap_b32 v101, v103
    buffer_store_dwordx4 v[100:103], v118, s[20:23], 0 offen offset:0 sc1
    v_permlane32_swap_b32 v104, v106
    v_permlane32_swap_b32 v105, v107
    buffer_store_dwordx4 v[104:107], v118, s[20:23], 0 offen offset:1024 sc1
    s_waitcnt lgkmcnt(1)
    v_pk_fma_f32 v[28:29], v[92:93], v[134:135], v[28:29] op_sel:[0,0,0] op_sel_hi:[1,0,1]
    v_pk_fma_f32 v[30:31], v[94:95], v[134:135], v[30:31] op_sel:[0,0,0] op_sel_hi:[1,0,1]
    v_pk_mul_f32 v[28:29], v[28:29], v[134:135] op_sel:[0,1] op_sel_hi:[1,1]
    v_pk_mul_f32 v[30:31], v[30:31], v[134:135] op_sel:[0,1] op_sel_hi:[1,1]
    v_cvt_pk_bf16_f32 v124, v28, v29
    v_cvt_pk_bf16_f32 v125, v30, v31
    s_waitcnt lgkmcnt(0)
    v_pk_fma_f32 v[32:33], v[96:97], v[134:135], v[32:33] op_sel:[0,0,0] op_sel_hi:[1,0,1]
    v_pk_fma_f32 v[34:35], v[98:99], v[134:135], v[34:35] op_sel:[0,0,0] op_sel_hi:[1,0,1]
    v_pk_mul_f32 v[32:33], v[32:33], v[134:135] op_sel:[0,1] op_sel_hi:[1,1]
    v_pk_mul_f32 v[34:35], v[34:35], v[134:135] op_sel:[0,1] op_sel_hi:[1,1]
    v_cvt_pk_bf16_f32 v126, v32, v33
    v_cvt_pk_bf16_f32 v127, v34, v35
    v_pk_fma_f32 v[60:61], v[92:93], v[136:137], v[60:61] op_sel:[0,0,0] op_sel_hi:[1,0,1]
    v_pk_fma_f32 v[62:63], v[94:95], v[136:137], v[62:63] op_sel:[0,0,0] op_sel_hi:[1,0,1]
    v_pk_mul_f32 v[60:61], v[60:61], v[136:137] op_sel:[0,1] op_sel_hi:[1,1]
    v_pk_mul_f32 v[62:63], v[62:63], v[136:137] op_sel:[0,1] op_sel_hi:[1,1]
    v_cvt_pk_bf16_f32 v128, v60, v61
    v_cvt_pk_bf16_f32 v129, v62, v63
    v_pk_fma_f32 v[64:65], v[96:97], v[136:137], v[64:65] op_sel:[0,0,0] op_sel_hi:[1,0,1]
    v_pk_fma_f32 v[66:67], v[98:99], v[136:137], v[66:67] op_sel:[0,0,0] op_sel_hi:[1,0,1]
    v_pk_mul_f32 v[64:65], v[64:65], v[136:137] op_sel:[0,1] op_sel_hi:[1,1]
    v_pk_mul_f32 v[66:67], v[66:67], v[136:137] op_sel:[0,1] op_sel_hi:[1,1]
    v_cvt_pk_bf16_f32 v130, v64, v65
    v_cvt_pk_bf16_f32 v131, v66, v67
    s_bitcmp1_b32 s61, 6
    s_cbranch_scc0 k1_sp_9
    v_mov_b64 v[144:145], v[124:125]
    v_mov_b64 v[146:147], v[128:129]
    buffer_store_dwordx4 v[144:147], v123, s[20:23], 0 offen offset:2048 sc1
k1_sp_9:
    s_bitcmp1_b32 s61, 7
    s_cbranch_scc0 k1_sp_10
    v_mov_b64 v[144:145], v[126:127]
    v_mov_b64 v[146:147], v[130:131]
    buffer_store_dwordx4 v[144:147], v123, s[20:23], 0 offen offset:2048 sc1
k1_sp_10:
    v_permlane32_swap_b32 v124, v126
    v_permlane32_swap_b32 v125, v127
    buffer_store_dwordx4 v[124:127], v119, s[20:23], 0 offen offset:0 sc1
    v_permlane32_swap_b32 v128, v130
    v_permlane32_swap_b32 v129, v131
    buffer_store_dwordx4 v[128:131], v119, s[20:23], 0 offen offset:1024 sc1
    s_branch k1_out
k1_vpre:
    s_xor_b32 s31, s39, 0
    s_lshl_b32 s31, s31, 5
    s_sub_u32 s32, s29, 10
    s_lshl_b32 s32, s32, 7
    s_add_u32 s31, s31, s32
    v_add_u32 v159, s31, v154
    v_mul_u32_u24 v160, 3277, v159
    v_lshrrev_b32 v160, 16, v160
    v_mul_u32_u24 v161, 20, v160
    v_sub_u32 v159, v159, v161
    v_mul_u32_u24 v160, 167936, v160
    v_lshl_add_u32 v160, v159, 5, v160
    v_mul_u32_u24 v161, 16, v155
    v_add_u32 v116, v160, v161
    s_xor_b32 s31, s39, 1
    s_lshl_b32 s31, s31, 5
    s_sub_u32 s32, s29, 10
    s_lshl_b32 s32, s32, 7
    s_add_u32 s31, s31, s32
    v_add_u32 v159, s31, v154
    v_mul_u32_u24 v160, 3277, v159
    v_lshrrev_b32 v160, 16, v160
    v_mul_u32_u24 v161, 20, v160
    v_sub_u32 v159, v159, v161
    v_mul_u32_u24 v160, 167936, v160
    v_lshl_add_u32 v160, v159, 5, v160
    v_mul_u32_u24 v161, 16, v155
    v_add_u32 v117, v160, v161
    s_lshl_b32 s31, s28, 1
    s_add_u32 s31, s31, s33
    s_mul_i32 s31, s31, 5248
    s_add_u32 s40, s31, 2624000
    s_add_u32 s41, s40, 0
    s_add_u32 s42, s41, 640
    s_add_u32 s43, s40, 1280
    s_add_u32 s44, s43, 640
    s_mov_b32 s37, 0
    v_add_u32 v144, s35, v142
    v_add_u32 v152, s35, v143
    v_xor_b32 v148, 4096, v144
    v_xor_b32 v153, 64, v152
k1_vloop:
    s_waitcnt lgkmcnt(0)
    v_mfma_f32_32x32x16_bf16 v[4:19], v[76:79], v[92:95], v[4:19]
    s_barrier
    ds_read_b128 v[68:71], v144
    ds_read_b64_tr_b16 v[84:85], v152 offset:0
    v_xor_b32 v145, 32, v144
    v_xor_b32 v149, 32, v148
    v_mfma_f32_32x32x16_bf16 v[52:67], v[80:83], v[96:99], v[52:67]
    ds_read_b64_tr_b16 v[86:87], v152 offset:1024
    ds_read_b128 v[72:75], v148
    v_xor_b32 v146, 64, v144
    v_xor_b32 v150, 64, v148
    v_mfma_f32_32x32x16_bf16 v[20:35], v[76:79], v[96:99], v[20:35]
    ds_read_b64_tr_b16 v[88:89], v153 offset:0
    ds_read_b64_tr_b16 v[90:91], v153 offset:1024
    v_xor_b32 v147, 96, v144
    v_xor_b32 v151, 96, v148
    v_mfma_f32_32x32x16_bf16 v[36:51], v[80:83], v[92:95], v[36:51]
    v_mfma_f32_4x4x4bf16_1k v[100:103], v[132:133], v[92:93], v[100:103]
    v_mfma_f32_4x4x4bf16_1k v[104:107], v[132:133], v[94:95], v[104:107]
    s_waitcnt lgkmcnt(3)
    v_mfma_f32_4x4x4bf16_1k v[108:111], v[132:133], v[84:85], v[108:111]
    v_mfma_f32_4x4x4bf16_1k v[112:115], v[132:133], v[86:87], v[112:115]
    v_mfma_f32_32x32x16_bf16 v[4:19], v[68:71], v[84:87], v[4:19]
    ds_read_b128 v[76:79], v145
    ds_read_b64_tr_b16 v[92:93], v152 offset:4096
    s_add_u32 s35, s35, 32768
    s_waitcnt lgkmcnt(2)
    v_mfma_f32_32x32x16_bf16 v[52:67], v[72:75], v[88:91], v[52:67]
    ds_read_b64_tr_b16 v[94:95], v152 offset:5120
    ds_read_b128 v[80:83], v149
    s_and_b32 s35, s35, 0x1ffff
    v_mfma_f32_32x32x16_bf16 v[20:35], v[68:71], v[88:91], v[20:35]
    ds_read_b64_tr_b16 v[96:97], v153 offset:4096
    ds_read_b64_tr_b16 v[98:99], v153 offset:5120
    v_mfma_f32_32x32x16_bf16 v[36:51], v[72:75], v[84:87], v[36:51]
    s_waitcnt lgkmcnt(3)
    v_mfma_f32_32x32x16_bf16 v[4:19], v[76:79], v[92:95], v[4:19]
    ds_read_b128 v[68:71], v146
    ds_read_b64_tr_b16 v[84:85], v152 offset:8192
    s_waitcnt lgkmcnt(2)
    v_mfma_f32_32x32x16_bf16 v[52:67], v[80:83], v[96:99], v[52:67]
    ds_read_b64_tr_b16 v[86:87], v152 offset:9216
    ds_read_b128 v[72:75], v150
    v_mfma_f32_32x32x16_bf16 v[20:35], v[76:79], v[96:99], v[20:35]
    ds_read_b64_tr_b16 v[88:89], v153 offset:8192
    ds_read_b64_tr_b16 v[90:91], v153 offset:9216
    v_mfma_f32_32x32x16_bf16 v[36:51], v[80:83], v[92:95], v[36:51]
    v_mfma_f32_4x4x4bf16_1k v[100:103], v[132:133], v[92:93], v[100:103]
    v_mfma_f32_4x4x4bf16_1k v[104:107], v[132:133], v[94:95], v[104:107]
    s_waitcnt lgkmcnt(3)
    v_mfma_f32_4x4x4bf16_1k v[108:111], v[132:133], v[84:85], v[108:111]
    v_mfma_f32_4x4x4bf16_1k v[112:115], v[132:133], v[86:87], v[112:115]
    v_mfma_f32_32x32x16_bf16 v[4:19], v[68:71], v[84:87], v[4:19]
    ds_read_b128 v[76:79], v147
    ds_read_b64_tr_b16 v[92:93], v152 offset:12288
    ds_read_b64_tr_b16 v[94:95], v152 offset:13312
    s_add_u32 s37, s37, 1
    s_waitcnt lgkmcnt(3)
    v_mfma_f32_32x32x16_bf16 v[52:67], v[72:75], v[88:91], v[52:67]
    ds_read_b128 v[80:83], v151
    ds_read_b64_tr_b16 v[96:97], v153 offset:12288
    ds_read_b64_tr_b16 v[98:99], v153 offset:13312
    s_cmp_lt_u32 s37, 10
    v_mfma_f32_32x32x16_bf16 v[20:35], v[68:71], v[88:91], v[20:35]
    v_mfma_f32_32x32x16_bf16 v[36:51], v[72:75], v[84:87], v[36:51]
    v_add_u32 v144, s35, v142
    v_add_u32 v152, s35, v143
    v_xor_b32 v148, 4096, v144
    v_xor_b32 v153, 64, v152
    s_cbranch_scc1 k1_vloop
    s_waitcnt lgkmcnt(0)
    v_mfma_f32_32x32x16_bf16 v[4:19], v[76:79], v[92:95], v[4:19]
    v_mfma_f32_32x32x16_bf16 v[52:67], v[80:83], v[96:99], v[52:67]
    v_mfma_f32_32x32x16_bf16 v[20:35], v[76:79], v[96:99], v[20:35]
    v_mfma_f32_32x32x16_bf16 v[36:51], v[80:83], v[92:95], v[36:51]
    v_mfma_f32_4x4x4bf16_1k v[100:103], v[132:133], v[92:93], v[100:103]
    v_mfma_f32_4x4x4bf16_1k v[104:107], v[132:133], v[94:95], v[104:107]
    s_lshl_b32 s31, s39, 7
    s_add_u32 s31, s31, 132096
    v_lshl_add_u32 v157, v154, 2, s31
    v_add_f32 v108, v108, v112
    s_nop 0
    v_add_f32 v100, v100, v104
    v_add_f32 v100, v100, v108
    v_mov_b32 v158, v100
    s_nop 1
    v_permlane32_swap_b32 v100, v158
    s_nop 0
    v_add_f32 v100, v100, v158
    ds_write_b32 v157, v100
    s_waitcnt lgkmcnt(0)
    s_barrier
    s_xor_b32 s31, s39, 1
    s_lshl_b32 s31, s31, 7
    s_add_u32 s31, s31, 132096
    v_lshl_add_u32 v156, v154, 2, s31
    s_lshl_b32 s31, s38, 7
    s_add_u32 s31, s31, 131072
    v_lshl_add_u32 v157, v155, 4, s31
    v_xor_b32 v158, 128, v157
    ds_read_b32 v137, v156
    v_mov_b32 v136, v100
    ds_read_b128 v[68:71], v157 offset:0
    ds_read_b128 v[84:87], v157 offset:512
    ds_read_b128 v[72:75], v157 offset:32
    ds_read_b128 v[88:91], v157 offset:544
    ds_read_b128 v[76:79], v157 offset:64
    ds_read_b128 v[92:95], v157 offset:576
    ds_read_b128 v[80:83], v157 offset:96
    ds_read_b128 v[96:99], v157 offset:608
    s_waitcnt lgkmcnt(4)
    v_pk_fma_f32 v[4:5], v[68:69], v[136:137], v[4:5] op_sel:[0,0,0] op_sel_hi:[1,0,1]
    v_pk_fma_f32 v[6:7], v[70:71], v[136:137], v[6:7] op_sel:[0,0,0] op_sel_hi:[1,0,1]
    v_pk_fma_f32 v[8:9], v[72:73], v[136:137], v[8:9] op_sel:[0,0,0] op_sel_hi:[1,0,1]
    v_pk_fma_f32 v[10:11], v[74:75], v[136:137], v[10:11] op_sel:[0,0,0] op_sel_hi:[1,0,1]
    v_pk_mul_f32 v[4:5], v[4:5], v[84:85]
    v_pk_mul_f32 v[6:7], v[6:7], v[86:87]
    v_pk_mul_f32 v[8:9], v[8:9], v[88:89]
    v_pk_mul_f32 v[10:11], v[10:11], v[90:91]
    v_cvt_pk_bf16_f32 v120, v4, v5
    v_cvt_pk_bf16_f32 v121, v6, v7
    v_cvt_pk_bf16_f32 v122, v8, v9
    v_cvt_pk_bf16_f32 v123, v10, v11
    buffer_store_dwordx4 v[120:123], v116, s[20:23], s41 offen sc1
    v_pk_fma_f32 v[20:21], v[68:69], v[136:137], v[20:21] op_sel:[0,1,0] op_sel_hi:[1,1,1]
    v_pk_fma_f32 v[22:23], v[70:71], v[136:137], v[22:23] op_sel:[0,1,0] op_sel_hi:[1,1,1]
    v_pk_fma_f32 v[24:25], v[72:73], v[136:137], v[24:25] op_sel:[0,1,0] op_sel_hi:[1,1,1]
    v_pk_fma_f32 v[26:27], v[74:75], v[136:137], v[26:27] op_sel:[0,1,0] op_sel_hi:[1,1,1]
    v_pk_mul_f32 v[20:21], v[20:21], v[84:85]
    v_pk_mul_f32 v[22:23], v[22:23], v[86:87]
    v_pk_mul_f32 v[24:25], v[24:25], v[88:89]
    v_pk_mul_f32 v[26:27], v[26:27], v[90:91]
    v_cvt_pk_bf16_f32 v124, v20, v21
    v_cvt_pk_bf16_f32 v125, v22, v23
    v_cvt_pk_bf16_f32 v126, v24, v25
    v_cvt_pk_bf16_f32 v127, v26, v27
    buffer_store_dwordx4 v[124:127], v117, s[20:23], s41 offen sc1
    s_waitcnt lgkmcnt(0)
    v_pk_fma_f32 v[12:13], v[76:77], v[136:137], v[12:13] op_sel:[0,0,0] op_sel_hi:[1,0,1]
    v_pk_fma_f32 v[14:15], v[78:79], v[136:137], v[14:15] op_sel:[0,0,0] op_sel_hi:[1,0,1]
    v_pk_fma_f32 v[16:17], v[80:81], v[136:137], v[16:17] op_sel:[0,0,0] op_sel_hi:[1,0,1]
    v_pk_fma_f32 v[18:19], v[82:83], v[136:137], v[18:19] op_sel:[0,0,0] op_sel_hi:[1,0,1]
    v_pk_mul_f32 v[12:13], v[12:13], v[92:93]
    v_pk_mul_f32 v[14:15], v[14:15], v[94:95]
    v_pk_mul_f32 v[16:17], v[16:17], v[96:97]
    v_pk_mul_f32 v[18:19], v[18:19], v[98:99]
    v_cvt_pk_bf16_f32 v128, v12, v13
    v_cvt_pk_bf16_f32 v129, v14, v15
    v_cvt_pk_bf16_f32 v130, v16, v17
    v_cvt_pk_bf16_f32 v131, v18, v19
    buffer_store_dwordx4 v[128:131], v116, s[20:23], s42 offen sc1
    v_pk_fma_f32 v[28:29], v[76:77], v[136:137], v[28:29] op_sel:[0,1,0] op_sel_hi:[1,1,1]
    v_pk_fma_f32 v[30:31], v[78:79], v[136:137], v[30:31] op_sel:[0,1,0] op_sel_hi:[1,1,1]
    v_pk_fma_f32 v[32:33], v[80:81], v[136:137], v[32:33] op_sel:[0,1,0] op_sel_hi:[1,1,1]
    v_pk_fma_f32 v[34:35], v[82:83], v[136:137], v[34:35] op_sel:[0,1,0] op_sel_hi:[1,1,1]
    v_pk_mul_f32 v[28:29], v[28:29], v[92:93]
    v_pk_mul_f32 v[30:31], v[30:31], v[94:95]
    v_pk_mul_f32 v[32:33], v[32:33], v[96:97]
    v_pk_mul_f32 v[34:35], v[34:35], v[98:99]
    v_cvt_pk_bf16_f32 v120, v28, v29
    v_cvt_pk_bf16_f32 v121, v30, v31
    v_cvt_pk_bf16_f32 v122, v32, v33
    v_cvt_pk_bf16_f32 v123, v34, v35
    buffer_store_dwordx4 v[120:123], v117, s[20:23], s42 offen sc1
    ds_read_b128 v[68:71], v158 offset:0
    ds_read_b128 v[84:87], v158 offset:512
    ds_read_b128 v[72:75], v158 offset:32
    ds_read_b128 v[88:91], v158 offset:544
    ds_read_b128 v[76:79], v158 offset:64
    ds_read_b128 v[92:95], v158 offset:576
    ds_read_b128 v[80:83], v158 offset:96
    ds_read_b128 v[96:99], v158 offset:608
    s_waitcnt lgkmcnt(4)
    v_pk_fma_f32 v[36:37], v[68:69], v[136:137], v[36:37] op_sel:[0,0,0] op_sel_hi:[1,0,1]
    v_pk_fma_f32 v[38:39], v[70:71], v[136:137], v[38:39] op_sel:[0,0,0] op_sel_hi:[1,0,1]
    v_pk_fma_f32 v[40:41], v[72:73], v[136:137], v[40:41] op_sel:[0,0,0] op_sel_hi:[1,0,1]
    v_pk_fma_f32 v[42:43], v[74:75], v[136:137], v[42:43] op_sel:[0,0,0] op_sel_hi:[1,0,1]
    v_pk_mul_f32 v[36:37], v[36:37], v[84:85]
    v_pk_mul_f32 v[38:39], v[38:39], v[86:87]
    v_pk_mul_f32 v[40:41], v[40:41], v[88:89]
    v_pk_mul_f32 v[42:43], v[42:43], v[90:91]
    v_cvt_pk_bf16_f32 v124, v36, v37
    v_cvt_pk_bf16_f32 v125, v38, v39
    v_cvt_pk_bf16_f32 v126, v40, v41
    v_cvt_pk_bf16_f32 v127, v42, v43
    buffer_store_dwordx4 v[124:127], v116, s[20:23], s43 offen sc1
    v_pk_fma_f32 v[52:53], v[68:69], v[136:137], v[52:53] op_sel:[0,1,0] op_sel_hi:[1,1,1]
    v_pk_fma_f32 v[54:55], v[70:71], v[136:137], v[54:55] op_sel:[0,1,0] op_sel_hi:[1,1,1]
    v_pk_fma_f32 v[56:57], v[72:73], v[136:137], v[56:57] op_sel:[0,1,0] op_sel_hi:[1,1,1]
    v_pk_fma_f32 v[58:59], v[74:75], v[136:137], v[58:59] op_sel:[0,1,0] op_sel_hi:[1,1,1]
    v_pk_mul_f32 v[52:53], v[52:53], v[84:85]
    v_pk_mul_f32 v[54:55], v[54:55], v[86:87]
    v_pk_mul_f32 v[56:57], v[56:57], v[88:89]
    v_pk_mul_f32 v[58:59], v[58:59], v[90:91]
    v_cvt_pk_bf16_f32 v128, v52, v53
    v_cvt_pk_bf16_f32 v129, v54, v55
    v_cvt_pk_bf16_f32 v130, v56, v57
    v_cvt_pk_bf16_f32 v131, v58, v59
    buffer_store_dwordx4 v[128:131], v117, s[20:23], s43 offen sc1
    s_waitcnt lgkmcnt(0)
    v_pk_fma_f32 v[44:45], v[76:77], v[136:137], v[44:45] op_sel:[0,0,0] op_sel_hi:[1,0,1]
    v_pk_fma_f32 v[46:47], v[78:79], v[136:137], v[46:47] op_sel:[0,0,0] op_sel_hi:[1,0,1]
    v_pk_fma_f32 v[48:49], v[80:81], v[136:137], v[48:49] op_sel:[0,0,0] op_sel_hi:[1,0,1]
    v_pk_fma_f32 v[50:51], v[82:83], v[136:137], v[50:51] op_sel:[0,0,0] op_sel_hi:[1,0,1]
    v_pk_mul_f32 v[44:45], v[44:45], v[92:93]
    v_pk_mul_f32 v[46:47], v[46:47], v[94:95]
    v_pk_mul_f32 v[48:49], v[48:49], v[96:97]
    v_pk_mul_f32 v[50:51], v[50:51], v[98:99]
    v_cvt_pk_bf16_f32 v120, v44, v45
    v_cvt_pk_bf16_f32 v121, v46, v47
    v_cvt_pk_bf16_f32 v122, v48, v49
    v_cvt_pk_bf16_f32 v123, v50, v51
    buffer_store_dwordx4 v[120:123], v116, s[20:23], s44 offen sc1
    v_pk_fma_f32 v[60:61], v[76:77], v[136:137], v[60:61] op_sel:[0,1,0] op_sel_hi:[1,1,1]
    v_pk_fma_f32 v[62:63], v[78:79], v[136:137], v[62:63] op_sel:[0,1,0] op_sel_hi:[1,1,1]
    v_pk_fma_f32 v[64:65], v[80:81], v[136:137], v[64:65] op_sel:[0,1,0] op_sel_hi:[1,1,1]
    v_pk_fma_f32 v[66:67], v[82:83], v[136:137], v[66:67] op_sel:[0,1,0] op_sel_hi:[1,1,1]
    v_pk_mul_f32 v[60:61], v[60:61], v[92:93]
    v_pk_mul_f32 v[62:63], v[62:63], v[94:95]
    v_pk_mul_f32 v[64:65], v[64:65], v[96:97]
    v_pk_mul_f32 v[66:67], v[66:67], v[98:99]
    v_cvt_pk_bf16_f32 v124, v60, v61
    v_cvt_pk_bf16_f32 v125, v62, v63
    v_cvt_pk_bf16_f32 v126, v64, v65
    v_cvt_pk_bf16_f32 v127, v66, v67
    buffer_store_dwordx4 v[124:127], v117, s[20:23], s44 offen sc1
    s_branch k1_out
k1_aux:
    s_load_dwordx2 s[10:11], s[0:1], 32
    s_load_dwordx2 s[54:55], s[0:1], 72
    s_cmp_ge_u32 s30, 8
    s_cbranch_scc1 k1_aux_side
k1_aux_rows:
    s_cmp_lg_u32 s30, 0
    s_cbranch_scc1 k1_out
    s_waitcnt lgkmcnt(0)
    s_mov_b32 s20, s8
    s_and_b32 s21, s9, 0xffff
    s_mov_b32 s22, 16777216
    s_mov_b32 s23, 0x00020000
    s_mov_b32 s16, s54
    s_and_b32 s17, s55, 0xffff
    s_mov_b32 s18, 256
    s_mov_b32 s19, 0x00020000
    v_mov_b32 v148, 0
    s_lshl_b32 s31, s28, 9
    s_add_u32 s31, s31, 12622208
    s_lshl_b32 s32, s28, 9
    s_add_u32 s32, s32, 12706816
    v_lshlrev_b32 v117, 3, v0
    s_barrier
    s_mov_b64 exec, 1
    s_mov_b32 s33, 0
k1_a_poll:
    v_mov_b32 v121, 0
    buffer_atomic_add v121, v148, s[20:23], s31 offen sc0 sc1
    s_waitcnt vmcnt(0)
    v_cmp_ne_u32 vcc, 32, v121
    s_add_u32 s33, s33, 1
    s_cmp_gt_u32 s33, 0x4000
    s_cbranch_scc1 k1_a_poll_ok
    s_nop 1
    s_cbranch_vccz k1_a_poll_ok
    s_sleep 8
    s_branch k1_a_poll
k1_a_poll_ok:
    s_mov_b64 exec, -1
    buffer_load_dwordx2 v[126:127], v117, s[20:23], s32 offen sc1
    v_mov_b32 v119, 0
    s_waitcnt vmcnt(0)
    s_branch k1_aux_sel
    s_branch attn_kernel
k1_aux_side:
    v_lshrrev_b32 v118, 4, v0
    s_sub_u32 s31, s30, 8
    s_lshl_b32 s31, s31, 3
    v_add_u32 v120, s31, v118
    v_mul_u32_u24 v120, 167936, v120
    v_bfe_u32 v121, v0, 3, 1
    v_mul_u32_u24 v121, 5248, v121
    v_and_b32 v122, 7, v0
    v_lshlrev_b32 v122, 4, v122
    v_add3_u32 v120, v120, v121, v122
    s_mul_i32 s31, s28, 10496
    s_add_u32 s31, s31, 2626560
    s_add_u32 s32, s31, 671744
    v_mov_b32 v128, 0x3f803f80
    v_mov_b32 v129, 0x3f803f80
    v_mov_b32 v130, 0x3f803f80
    v_mov_b32 v131, 0x3f803f80
    v_mov_b64 v[4:5], 0
    v_mov_b64 v[6:7], 0
    v_lshlrev_b32 v121, 4, v0
    s_waitcnt lgkmcnt(0)
    s_mov_b32 s20, s8
    s_and_b32 s21, s9, 0xffff
    s_mov_b32 s22, 16777216
    s_mov_b32 s23, 0x00020000
    s_mov_b32 s24, s54
    s_and_b32 s25, s55, 0xffff
    s_mov_b32 s26, 256
    s_mov_b32 s27, 0x00020000
    s_lshl_b32 s33, s28, 4
    s_add_u32 s33, s33, s30
    s_cmp_lg_u32 s33, 8
    s_cbranch_scc1 k1_aux_nz
    s_mov_b32 s33, 12583936
    buffer_store_dwordx4 v[4:7], v121, s[20:23], s33 offen offset:0 sc1
    buffer_store_dwordx4 v[4:7], v121, s[20:23], s33 offen offset:1024 sc1
    buffer_store_dwordx4 v[4:7], v121, s[20:23], s33 offen offset:2048 sc1
    buffer_store_dwordx4 v[4:7], v121, s[20:23], s33 offen offset:3072 sc1
    s_add_u32 s33, s33, 4096
    buffer_store_dwordx4 v[4:7], v121, s[20:23], s33 offen offset:0 sc1
    buffer_store_dwordx4 v[4:7], v121, s[20:23], s33 offen offset:1024 sc1
    buffer_store_dwordx4 v[4:7], v121, s[20:23], s33 offen offset:2048 sc1
    buffer_store_dwordx4 v[4:7], v121, s[20:23], s33 offen offset:3072 sc1
    s_add_u32 s33, s33, 4096
    buffer_store_dwordx4 v[4:7], v121, s[20:23], s33 offen offset:0 sc1
    buffer_store_dwordx4 v[4:7], v121, s[20:23], s33 offen offset:1024 sc1
    buffer_store_dwordx4 v[4:7], v121, s[20:23], s33 offen offset:2048 sc1
    buffer_store_dwordx4 v[4:7], v121, s[20:23], s33 offen offset:3072 sc1
    s_add_u32 s33, s33, 4096
    buffer_store_dwordx4 v[4:7], v121, s[20:23], s33 offen offset:0 sc1
    buffer_store_dwordx4 v[4:7], v121, s[20:23], s33 offen offset:1024 sc1
    buffer_store_dwordx4 v[4:7], v121, s[20:23], s33 offen offset:2048 sc1
    buffer_store_dwordx4 v[4:7], v121, s[20:23], s33 offen offset:3072 sc1
    s_add_u32 s33, s33, 4096
    buffer_store_dwordx4 v[4:7], v121, s[20:23], s33 offen offset:0 sc1
    buffer_store_dwordx4 v[4:7], v121, s[20:23], s33 offen offset:1024 sc1
    buffer_store_dwordx4 v[4:7], v121, s[20:23], s33 offen offset:2048 sc1
    buffer_store_dwordx4 v[4:7], v121, s[20:23], s33 offen offset:3072 sc1
    s_add_u32 s33, s33, 4096
    buffer_store_dwordx4 v[4:7], v121, s[20:23], s33 offen offset:0 sc1
    buffer_store_dwordx4 v[4:7], v121, s[20:23], s33 offen offset:1024 sc1
    buffer_store_dwordx4 v[4:7], v121, s[20:23], s33 offen offset:2048 sc1
    buffer_store_dwordx4 v[4:7], v121, s[20:23], s33 offen offset:3072 sc1
    s_add_u32 s33, s33, 4096
    buffer_store_dwordx4 v[4:7], v121, s[20:23], s33 offen offset:0 sc1
    buffer_store_dwordx4 v[4:7], v121, s[20:23], s33 offen offset:1024 sc1
    buffer_store_dwordx4 v[4:7], v121, s[20:23], s33 offen offset:2048 sc1
    buffer_store_dwordx4 v[4:7], v121, s[20:23], s33 offen offset:3072 sc1
    s_add_u32 s33, s33, 4096
    buffer_store_dwordx4 v[4:7], v121, s[20:23], s33 offen offset:0 sc1
    buffer_store_dwordx4 v[4:7], v121, s[20:23], s33 offen offset:1024 sc1
    buffer_store_dwordx4 v[4:7], v121, s[20:23], s33 offen offset:2048 sc1
    buffer_store_dwordx4 v[4:7], v121, s[20:23], s33 offen offset:3072 sc1
    s_add_u32 s33, s33, 4096
    buffer_store_dwordx4 v[4:7], v121, s[20:23], s33 offen offset:0 sc1
    buffer_store_dwordx4 v[4:7], v121, s[20:23], s33 offen offset:1024 sc1
    buffer_store_dwordx4 v[4:7], v121, s[20:23], s33 offen offset:2048 sc1
    buffer_store_dwordx4 v[4:7], v121, s[20:23], s33 offen offset:3072 sc1
    s_add_u32 s33, s33, 4096
    buffer_store_dwordx4 v[4:7], v121, s[20:23], s33 offen offset:0 sc1
    buffer_store_dwordx4 v[4:7], v121, s[20:23], s33 offen offset:1024 sc1
    buffer_store_dwordx4 v[4:7], v121, s[20:23], s33 offen offset:2048 sc1
    buffer_store_dwordx4 v[4:7], v121, s[20:23], s33 offen offset:3072 sc1
    s_add_u32 s33, s33, 4096
    buffer_store_dwordx4 v[4:7], v121, s[20:23], s33 offen offset:0 sc1
    buffer_store_dwordx4 v[4:7], v121, s[20:23], s33 offen offset:1024 sc1
    buffer_store_dwordx4 v[4:7], v121, s[20:23], s33 offen offset:2048 sc1
    buffer_store_dwordx4 v[4:7], v121, s[20:23], s33 offen offset:3072 sc1
    s_add_u32 s33, s33, 4096
    buffer_store_dwordx4 v[4:7], v121, s[20:23], s33 offen offset:0 sc1
    v_mov_b32 v123, 1
    s_waitcnt vmcnt(0)
    s_mov_b64 exec, 1
    buffer_store_dword v123, v121, s[24:27], 0 offen offset:4 sc1
    s_mov_b64 exec, -1
k1_aux_nz:
    buffer_store_dwordx4 v[128:131], v120, s[20:23], s31 offen sc1
    buffer_store_dwordx4 v[128:131], v120, s[20:23], s32 offen sc1
    s_cmp_lg_u32 s30, 8
    s_cbranch_scc1 k1_out
    v_mov_b32 v1, 0
    s_mov_b32 s33, 0
k1_z1:
    buffer_load_dword v2, v1, s[24:27], 0 offen offset:4 sc1
    s_add_u32 s33, s33, 1
    s_waitcnt vmcnt(0)
    v_readfirstlane_b32 s34, v2
    s_cmp_gt_u32 s33, 0x4000
    s_cbranch_scc1 k1_z1_ok
    s_cmp_lg_u32 s34, 0
    s_cbranch_scc1 k1_z1_ok
    s_sleep 8
    s_branch k1_z1
k1_z1_ok:
    s_branch k1_sig
k1_aux_ones:
    s_lshl_b32 s31, s30, 2
    v_add_u32 v120, s31, v118
    v_mul_u32_u24 v120, 167936, v120
    v_bfe_u32 v121, v0, 3, 1
    v_mul_u32_u24 v121, 5248, v121
    v_and_b32 v122, 7, v0
    v_lshlrev_b32 v122, 4, v122
    v_add3_u32 v120, v120, v121, v122
    s_mul_i32 s31, s28, 10496
    s_add_u32 s31, s31, 2626560
    v_mov_b32 v128, s36
    v_mov_b32 v129, s36
    v_mov_b32 v130, s36
    v_mov_b32 v131, s36
    buffer_store_dwordx4 v[128:131], v120, s[20:23], s31 offen sc1
    s_lshl_b32 s31, s28, 3
    s_add_u32 s31, s31, s30
    s_lshl_b32 s31, s31, 6
    s_add_u32 s31, s31, 12583936
    v_lshlrev_b32 v120, 4, v0
    v_mov_b64 v[4:5], 0
    v_mov_b64 v[6:7], 0
    s_mov_b64 exec, 15
    buffer_store_dwordx4 v[4:7], v120, s[20:23], s31 offen sc1
    s_endpgm
k1_aux_top:
    v_lshlrev_b32 v117, 3, v0
    ds_read_b64 v[126:127], v117
    v_mov_b32 v119, 0
    s_waitcnt lgkmcnt(0)
k1_aux_sel:
    v_max_u32 v120, v126, v127
    v_min_u32 v127, v126, v127
    v_mov_b32 v126, v120
    s_mov_b32 m0, 0
k1_topk:
    s_nop 0
    v_max_u32_dpp v120, v126, v126 row_ror:8 row_mask:0xf bank_mask:0xf
    s_nop 1
    v_max_u32_dpp v120, v120, v120 row_ror:4 row_mask:0xf bank_mask:0xf
    s_nop 1
    v_max_u32_dpp v120, v120, v120 row_ror:2 row_mask:0xf bank_mask:0xf
    s_nop 1
    v_max_u32_dpp v120, v120, v120 row_ror:1 row_mask:0xf bank_mask:0xf
    s_nop 1
    v_max_u32_dpp v120, v120, v120 row_bcast:15 row_mask:0xa bank_mask:0xf
    s_nop 1
    v_max_u32_dpp v120, v120, v120 row_bcast:31 row_mask:0xc bank_mask:0xf
    s_nop 0
    v_readlane_b32 s40, v120, 63
    s_nop 1
    v_cmp_eq_u32 vcc, s40, v126
    v_writelane_b32 v119, s40, m0
    s_add_u32 m0, m0, 1
    v_cndmask_b32 v126, v126, v127, vcc
    s_cmp_lt_u32 m0, 8
    v_cndmask_b32 v127, v127, 0, vcc
    s_cbranch_scc1 k1_topk
    v_lshlrev_b32 v117, 2, v0
    s_lshl_b32 s31, s28, 5
    s_add_u32 s31, s31, 12562432
    s_mov_b64 exec, 0xff
    buffer_store_dword v119, v117, s[20:23], s31 offen sc1
    s_mov_b64 exec, 1
    v_mov_b32 v118, 1
    s_waitcnt vmcnt(0)
    buffer_atomic_add v118, v148, s[16:19], 0 offen sc0 sc1
    s_waitcnt vmcnt(0)
    v_readfirstlane_b32 s40, v118
    s_mov_b64 exec, -1
    s_cmp_lg_u32 s40, 15
    s_cbranch_scc1 k1_aux_done
    v_lshlrev_b32 v118, 3, v0
    s_mov_b32 s31, 12562432
    buffer_load_dwordx2 v[126:127], v118, s[20:23], s31 offen sc1
    s_waitcnt vmcnt(0)
    v_max_u32 v120, v126, v127
    v_min_u32 v127, v126, v127
    v_mov_b32 v126, v120
    s_mov_b32 m0, 0
k1_topk2:
    s_nop 0
    v_max_u32_dpp v120, v126, v126 row_ror:8 row_mask:0xf bank_mask:0xf
    s_nop 1
    v_max_u32_dpp v120, v120, v120 row_ror:4 row_mask:0xf bank_mask:0xf
    s_nop 1
    v_max_u32_dpp v120, v120, v120 row_ror:2 row_mask:0xf bank_mask:0xf
    s_nop 1
    v_max_u32_dpp v120, v120, v120 row_ror:1 row_mask:0xf bank_mask:0xf
    s_nop 1
    v_max_u32_dpp v120, v120, v120 row_bcast:15 row_mask:0xa bank_mask:0xf
    s_nop 1
    v_max_u32_dpp v120, v120, v120 row_bcast:31 row_mask:0xc bank_mask:0xf
    s_nop 0
    v_readlane_b32 s40, v120, 63
    s_nop 1
    v_cmp_eq_u32 vcc, s40, v126
    v_writelane_b32 v119, s40, m0
    s_add_u32 m0, m0, 1
    v_cndmask_b32 v126, v126, v127, vcc
    s_cmp_lt_u32 m0, 8
    v_cndmask_b32 v127, v127, 0, vcc
    s_cbranch_scc1 k1_topk2
    s_mov_b32 s31, 12562944
    s_mov_b64 exec, 0xff
    buffer_store_dword v119, v117, s[20:23], s31 offen sc1
    s_mov_b64 exec, 1
    v_mov_b32 v118, 1
    s_waitcnt vmcnt(0)
    buffer_store_dword v118, v148, s[16:19], 0 offen offset:8 sc1
k1_aux_done:
    s_branch attn_kernel
    s_mov_b64 exec, -1
    v_lshrrev_b32 v118, 4, v0
    s_lshl_b32 s31, s30, 2
    v_add_u32 v120, s31, v118
    v_mul_u32_u24 v120, 167936, v120
    v_bfe_u32 v121, v0, 3, 1
    v_mul_u32_u24 v121, 5248, v121
    v_and_b32 v122, 7, v0
    v_lshlrev_b32 v122, 4, v122
    v_add3_u32 v120, v120, v121, v122
    s_mul_i32 s31, s28, 10496
    s_add_u32 s31, s31, 2626560
    v_mov_b32 v128, s36
    v_mov_b32 v129, s36
    v_mov_b32 v130, s36
    v_mov_b32 v131, s36
    buffer_store_dwordx4 v[128:131], v120, s[20:23], s31 offen sc1
    s_lshl_b32 s31, s28, 3
    s_add_u32 s31, s31, s30
    s_lshl_b32 s31, s31, 6
    s_add_u32 s31, s31, 12583936
    v_lshlrev_b32 v120, 4, v0
    v_mov_b64 v[4:5], 0
    v_mov_b64 v[6:7], 0
    s_mov_b64 exec, 15
    buffer_store_dwordx4 v[4:7], v120, s[20:23], s31 offen sc1
k1_end:
    s_endpgm
.p2align 6
attn_kernel:
    s_mov_b64 exec, -1
    s_setprio 0
    s_load_dwordx2 s[4:5], s[0:1], 80
    s_load_dwordx2 s[6:7], s[0:1], 0
    s_load_dwordx2 s[8:9], s[0:1], 64
    s_mov_b32 s38, s30
    s_and_b32 s40, s2, 7
    s_lshl_b32 s40, s40, 2
    s_lshr_b32 s41, s2, 6
    s_add_u32 s36, s40, s41
    s_bfe_u32 s37, s2, 0x30003
    s_cmp_ge_u32 s38, 8
    s_cbranch_scc1 k2_helpers
k2_compute:
    s_setprio 2
    s_and_b32 s40, s38, 3
    s_lshr_b32 s41, s38, 2
    v_lshlrev_b32 v140, 4, v0
    v_and_b32 v149, 31, v0
    v_lshlrev_b32 v141, 3, v149
    s_lshl_b32 s44, s37, 3
    s_lshl_b32 s45, s40, 1
    s_add_u32 s44, s44, s45
    s_add_u32 s43, s44, s41
    s_mul_i32 s46, s36, 81920
    s_mul_i32 s47, s37, 10240
    s_add_u32 s46, s46, s47
    s_mul_i32 s50, s36, 167936
    s_add_u32 s50, s50, 2621440
    s_lshl_b32 s51, s38, 10
    s_add_u32 s52, s51, 57344
    s_add_u32 s53, s51, s50
    s_add_u32 s54, s53, 16384
    s_add_u32 s55, s51, 121856
    s_add_u32 s47, s51, s46
    s_sub_u32 s48, s47, 5120
    s_cmp_ge_u32 s38, 5
    s_cselect_b32 s59, s55, s52
    s_cselect_b32 s39, s48, s54
    s_add_u32 s48, s51, 3072
    s_min_u32 s48, s48, 9216
    s_add_u32 s49, s48, s46
    s_add_u32 s48, s48, 126976
    s_add_u32 s51, s51, 40960
    s_add_u32 s58, s53, 8192
    s_waitcnt lgkmcnt(0)
    s_mov_b32 s16, s4
    s_and_b32 s17, s5, 0xffff
    s_mov_b32 s18, 16777216
    s_mov_b32 s19, 0x00020000
    s_mul_i32 s44, s41, 10496
    s_add_u32 s44, s44, 40960
    v_add_u32 v128, s44, v140
    v_lshrrev_b32 v151, 5, v0
    v_lshlrev_b32 v143, 18, v151
    v_lshl_add_u32 v129, v149, 4, s44
    v_add_u32 v129, v129, v143
    v_lshlrev_b32 v151, 4, v151
    v_lshl_add_u32 v142, v149, 5, v151
    s_mov_b32 s54, 0x000fffff
    s_mov_b32 s55, s54
    s_mov_b32 s56, 0x01100000
    s_mov_b32 s57, s56
    s_add_u32 s45, s44, 5120
    v_mov_b32 v150, 0x40000
    v_mov_b32 v151, s45
    v_cndmask_b32 v150, v150, v151, s[56:57]
    s_add_u32 s45, s44, 2560
    v_add_u32 v130, s45, v142
    v_cndmask_b32 v130, v150, v130, s[54:55]
    s_add_u32 s45, s44, 3200
    v_add_u32 v131, s45, v142
    v_cndmask_b32 v131, v150, v131, s[54:55]
    s_add_u32 s45, s44, 3840
    v_add_u32 v132, s45, v142
    v_cndmask_b32 v132, v150, v132, s[54:55]
    s_add_u32 s45, s44, 4480
    v_add_u32 v133, s45, v142
    v_cndmask_b32 v133, v150, v133, s[54:55]
    v_add_u32 v134, 43008, v128
    v_add_u32 v135, 43008, v129
    v_add_u32 v136, 43008, v130
    v_add_u32 v137, 43008, v131
    v_add_u32 v138, 43008, v132
    v_add_u32 v139, 43008, v133
    v_mov_b64 v[4:5], 0
    v_mov_b64 v[6:7], 0
    v_mov_b64 v[8:9], 0
    v_mov_b64 v[10:11], 0
    v_mov_b64 v[12:13], 0
    v_mov_b64 v[14:15], 0
    v_mov_b64 v[16:17], 0
    v_mov_b64 v[18:19], 0
    v_mov_b64 v[20:21], 0
    v_mov_b64 v[22:23], 0
    v_mov_b64 v[24:25], 0
    v_mov_b64 v[26:27], 0
    v_mov_b64 v[28:29], 0
    v_mov_b64 v[30:31], 0
    v_mov_b64 v[32:33], 0
    v_mov_b64 v[34:35], 0
    v_mov_b64 v[64:65], 0
    v_mov_b64 v[66:67], 0
    v_mov_b64 v[76:77], 0
    v_mov_b64 v[78:79], 0
    v_mov_b64 v[80:81], 0
    v_mov_b64 v[82:83], 0
    v_mov_b64 v[120:121], 0
    v_mov_b64 v[122:123], 0
    v_mov_b64 v[124:125], 0
    v_mov_b64 v[126:127], 0
    s_lshl_b32 s44, s38, 12
    s_add_u32 s44, s44, 126976
    v_add_u32 v147, s44, v140
    s_xor_b32 s45, s38, 4
    s_lshl_b32 s45, s45, 12
    s_add_u32 s45, s45, 126976
    v_add_u32 v148, s45, v140
    s_lshr_b32 s56, s43, 1
    s_mul_i32 s56, s56, 2560
    s_mul_i32 s57, s36, 81920
    s_add_u32 s56, s56, s57
    s_lshl_b32 s57, s41, 10
    s_add_u32 s63, s56, s57
    s_lshl_b32 s57, s41, 8
    s_add_u32 s60, s56, s57
    s_mov_b32 s42, 0
    s_mov_b32 s61, 4
    v_mov_b32 v144, 0
    v_mov_b32 v145, 160768
    s_lshl_b32 s44, s38, 2
    s_add_u32 s44, s44, 160800
    v_mov_b32 v146, s44
    s_mul_i32 s46, s40, 2560
    s_add_u32 s46, s46, 126976
    v_lshl_add_u32 v143, v141, 1, v143
    s_xor_b32 s44, s41, 1
    s_lshl_b32 s45, s44, 10
    s_add_u32 s45, s45, s46
    v_add_u32 v149, s45, v140
    s_lshl_b32 s45, s44, 3
    s_add_u32 s45, s45, s46
    v_add_u32 v151, s45, v143
    s_xor_b32 s44, s41, 0
    s_lshl_b32 s45, s44, 10
    s_add_u32 s45, s45, s46
    v_add_u32 v150, s45, v140
    s_lshl_b32 s45, s44, 3
    s_add_u32 s45, s45, s46
    v_add_u32 v152, s45, v143
    s_barrier
    s_mov_b32 m0, s51
    s_add_u32 s51, s51, 8192
    buffer_load_dwordx4 v140, s[16:19], s53 offen sc1 lds
    s_mov_b32 m0, s48
    s_nop 0
    buffer_load_dwordx4 v140, s[16:19], s49 offen sc1 lds
    s_mov_b32 m0, s51
    s_nop 0
    buffer_load_dwordx4 v140, s[16:19], s58 offen sc1 lds
    s_mov_b32 m0, s59
    s_nop 0
    buffer_load_dwordx4 v140, s[16:19], s39 offen sc1 lds
    s_waitcnt vmcnt(0)
    s_barrier
    ds_read_b128 v[84:87], v149
    ds_read_b64 v[92:93], v151 offset:2048
    ds_read_b128 v[96:99], v128
    ds_read_b128 v[104:107], v129 offset:2048
    ds_read_b128 v[88:91], v150
    ds_read_b64 v[94:95], v152 offset:2048
    ds_read_b128 v[100:103], v128 offset:1024
    ds_read_b128 v[112:115], v130
    ds_read_b128 v[116:119], v131
    s_waitcnt lgkmcnt(5)
    v_mfma_f32_32x32x16_bf16 v[36:51], v[96:99], v[84:87], 0
    v_mfma_f32_32x32x8bf16_1k v[36:51], v[104:105], v[92:93], v[36:51]
    s_waitcnt lgkmcnt(3)
    s_nop 10
.p2align 3
k2_loop:
    v_exp_f32 v36, v36
    v_mfma_f32_32x32x16_bf16 v[20:35], v[120:123], v[76:79], v[20:35]
    ds_read_b128 v[120:123], v132 offset:0
    v_exp_f32 v37, v37
    v_cvt_pk_bf16_f32 v82, v64, v65
    v_exp_f32 v38, v38
    v_exp_f32 v39, v39
    v_cvt_pk_bf16_f32 v83, v66, v67
    v_exp_f32 v40, v40
    v_mfma_f32_32x32x16_bf16 v[52:67], v[96:99], v[88:91], 0
    ds_read_b128 v[96:99], v128 offset:5248
    v_exp_f32 v41, v41
    v_cvt_pk_bf16_f32 v68, v36, v37
    v_exp_f32 v42, v42
    v_exp_f32 v43, v43
    v_mfma_f32_32x32x8bf16_1k v[52:67], v[104:105], v[94:95], v[52:67]
    v_cvt_pk_bf16_f32 v69, v38, v39
    v_exp_f32 v44, v44
    v_exp_f32 v45, v45
    v_cvt_pk_bf16_f32 v70, v40, v41
    v_exp_f32 v46, v46
    v_exp_f32 v47, v47
    v_cvt_pk_bf16_f32 v71, v42, v43
    v_mfma_f32_32x32x16_bf16 v[20:35], v[124:127], v[80:83], v[20:35]
    s_waitcnt lgkmcnt(2)
    ds_read_b128 v[124:127], v133 offset:0
    v_exp_f32 v48, v48
    v_exp_f32 v49, v49
    v_cvt_pk_bf16_f32 v72, v44, v45
    v_exp_f32 v50, v50
    v_exp_f32 v51, v51
    v_cvt_pk_bf16_f32 v73, v46, v47
    v_exp_f32 v52, v52
    v_mfma_f32_32x32x16_bf16 v[4:19], v[112:115], v[68:71], v[4:19]
    ds_read_b128 v[108:111], v129 offset:7296
    v_exp_f32 v53, v53
    v_cvt_pk_bf16_f32 v74, v48, v49
    v_exp_f32 v54, v54
    v_exp_f32 v55, v55
    v_cvt_pk_bf16_f32 v75, v50, v51
    v_exp_f32 v56, v56
    v_mfma_f32_32x32x16_bf16 v[36:51], v[100:103], v[84:87], 0
    v_exp_f32 v57, v57
    v_cvt_pk_bf16_f32 v76, v52, v53
    v_exp_f32 v58, v58
    v_exp_f32 v59, v59
    v_mfma_f32_32x32x8bf16_1k v[36:51], v[106:107], v[92:93], v[36:51]
    v_cvt_pk_bf16_f32 v77, v54, v55
    v_exp_f32 v60, v60
    v_exp_f32 v61, v61
    v_cvt_pk_bf16_f32 v78, v56, v57
    v_exp_f32 v62, v62
    v_exp_f32 v63, v63
    v_cvt_pk_bf16_f32 v79, v58, v59
    v_mfma_f32_32x32x16_bf16 v[4:19], v[116:119], v[72:75], v[4:19]
    v_exp_f32 v64, v64
    v_exp_f32 v65, v65
    v_cvt_pk_bf16_f32 v80, v60, v61
    v_exp_f32 v66, v66
    v_exp_f32 v67, v67
    v_cvt_pk_bf16_f32 v81, v62, v63
    v_exp_f32 v36, v36
    v_mfma_f32_32x32x16_bf16 v[20:35], v[112:115], v[76:79], v[20:35]
    ds_read_b128 v[112:115], v130 offset:5248
    v_exp_f32 v37, v37
    v_cvt_pk_bf16_f32 v82, v64, v65
    v_exp_f32 v38, v38
    v_exp_f32 v39, v39
    v_cvt_pk_bf16_f32 v83, v66, v67
    v_exp_f32 v40, v40
    v_mfma_f32_32x32x16_bf16 v[52:67], v[100:103], v[88:91], 0
    ds_read_b128 v[100:103], v128 offset:6272
    v_exp_f32 v41, v41
    v_cvt_pk_bf16_f32 v68, v36, v37
    v_exp_f32 v42, v42
    v_exp_f32 v43, v43
    v_mfma_f32_32x32x8bf16_1k v[52:67], v[106:107], v[94:95], v[52:67]
    v_cvt_pk_bf16_f32 v69, v38, v39
    v_exp_f32 v44, v44
    v_exp_f32 v45, v45
    v_cvt_pk_bf16_f32 v70, v40, v41
    v_exp_f32 v46, v46
    v_exp_f32 v47, v47
    v_cvt_pk_bf16_f32 v71, v42, v43
    v_mfma_f32_32x32x16_bf16 v[20:35], v[116:119], v[80:83], v[20:35]
    s_waitcnt lgkmcnt(2)
    ds_read_b128 v[116:119], v131 offset:5248
    v_exp_f32 v48, v48
    v_exp_f32 v49, v49
    v_cvt_pk_bf16_f32 v72, v44, v45
    v_exp_f32 v50, v50
    v_exp_f32 v51, v51
    v_cvt_pk_bf16_f32 v73, v46, v47
    v_exp_f32 v52, v52
    v_mfma_f32_32x32x16_bf16 v[4:19], v[120:123], v[68:71], v[4:19]
    v_exp_f32 v53, v53
    v_cvt_pk_bf16_f32 v74, v48, v49
    v_exp_f32 v54, v54
    v_exp_f32 v55, v55
    v_cvt_pk_bf16_f32 v75, v50, v51
    v_exp_f32 v56, v56
    v_mfma_f32_32x32x16_bf16 v[36:51], v[96:99], v[84:87], 0
    ds_write_b32 v146, v144
    v_exp_f32 v57, v57
    v_cvt_pk_bf16_f32 v76, v52, v53
    v_exp_f32 v58, v58
    v_exp_f32 v59, v59
    v_mfma_f32_32x32x8bf16_1k v[36:51], v[108:109], v[92:93], v[36:51]
    v_cvt_pk_bf16_f32 v77, v54, v55
    v_exp_f32 v60, v60
    v_exp_f32 v61, v61
    v_cvt_pk_bf16_f32 v78, v56, v57
    v_exp_f32 v62, v62
    v_exp_f32 v63, v63
    v_cvt_pk_bf16_f32 v79, v58, v59
    v_mfma_f32_32x32x16_bf16 v[4:19], v[124:127], v[72:75], v[4:19]
    v_exp_f32 v64, v64
    v_exp_f32 v65, v65
    v_cvt_pk_bf16_f32 v80, v60, v61
    v_exp_f32 v66, v66
    v_exp_f32 v67, v67
    v_cvt_pk_bf16_f32 v81, v62, v63
    v_exp_f32 v36, v36
    v_mfma_f32_32x32x16_bf16 v[20:35], v[120:123], v[76:79], v[20:35]
    s_cmp_lg_u32 s42, 0
    ds_read_b128 v[120:123], v132 offset:5248
    v_exp_f32 v37, v37
    v_cvt_pk_bf16_f32 v82, v64, v65
    s_cbranch_scc0 k2_wait1
k2_go1:
    v_exp_f32 v38, v38
    v_exp_f32 v39, v39
    v_cvt_pk_bf16_f32 v83, v66, v67
    v_exp_f32 v40, v40
    v_mfma_f32_32x32x16_bf16 v[52:67], v[96:99], v[88:91], 0
    ds_read_b128 v[96:99], v128 offset:21504
    v_exp_f32 v41, v41
    v_cvt_pk_bf16_f32 v68, v36, v37
    v_exp_f32 v42, v42
    v_exp_f32 v43, v43
    v_mfma_f32_32x32x8bf16_1k v[52:67], v[108:109], v[94:95], v[52:67]
    v_cvt_pk_bf16_f32 v69, v38, v39
    v_exp_f32 v44, v44
    v_exp_f32 v45, v45
    v_cvt_pk_bf16_f32 v70, v40, v41
    v_exp_f32 v46, v46
    v_exp_f32 v47, v47
    v_cvt_pk_bf16_f32 v71, v42, v43
    v_mfma_f32_32x32x16_bf16 v[20:35], v[124:127], v[80:83], v[20:35]
    s_waitcnt lgkmcnt(2)
    ds_read_b128 v[124:127], v133 offset:5248
    v_exp_f32 v48, v48
    v_exp_f32 v49, v49
    v_cvt_pk_bf16_f32 v72, v44, v45
    v_exp_f32 v50, v50
    v_exp_f32 v51, v51
    v_cvt_pk_bf16_f32 v73, v46, v47
    v_exp_f32 v52, v52
    v_mfma_f32_32x32x16_bf16 v[4:19], v[112:115], v[68:71], v[4:19]
    ds_read_b128 v[104:107], v129 offset:23552
    v_exp_f32 v53, v53
    v_cvt_pk_bf16_f32 v74, v48, v49
    v_exp_f32 v54, v54
    v_exp_f32 v55, v55
    v_cvt_pk_bf16_f32 v75, v50, v51
    v_exp_f32 v56, v56
    v_mfma_f32_32x32x16_bf16 v[36:51], v[100:103], v[84:87], 0
    v_exp_f32 v57, v57
    v_cvt_pk_bf16_f32 v76, v52, v53
    v_add_u32 v144, 1, v144
    v_exp_f32 v58, v58
    v_exp_f32 v59, v59
    v_mfma_f32_32x32x8bf16_1k v[36:51], v[110:111], v[92:93], v[36:51]
    v_cvt_pk_bf16_f32 v77, v54, v55
    v_exp_f32 v60, v60
    v_exp_f32 v61, v61
    v_cvt_pk_bf16_f32 v78, v56, v57
    v_exp_f32 v62, v62
    v_exp_f32 v63, v63
    v_cvt_pk_bf16_f32 v79, v58, v59
    v_mfma_f32_32x32x16_bf16 v[4:19], v[116:119], v[72:75], v[4:19]
    v_exp_f32 v64, v64
    v_exp_f32 v65, v65
    v_cvt_pk_bf16_f32 v80, v60, v61
    v_exp_f32 v66, v66
    v_exp_f32 v67, v67
    v_cvt_pk_bf16_f32 v81, v62, v63
    v_exp_f32 v36, v36
    v_mfma_f32_32x32x16_bf16 v[20:35], v[112:115], v[76:79], v[20:35]
    ds_read_b128 v[112:115], v130 offset:21504
    v_exp_f32 v37, v37
    v_cvt_pk_bf16_f32 v82, v64, v65
    v_exp_f32 v38, v38
    v_exp_f32 v39, v39
    v_cvt_pk_bf16_f32 v83, v66, v67
    v_exp_f32 v40, v40
    v_mfma_f32_32x32x16_bf16 v[52:67], v[100:103], v[88:91], 0
    ds_read_b128 v[100:103], v128 offset:22528
    v_exp_f32 v41, v41
    v_cvt_pk_bf16_f32 v68, v36, v37
    v_exp_f32 v42, v42
    v_exp_f32 v43, v43
    v_mfma_f32_32x32x8bf16_1k v[52:67], v[110:111], v[94:95], v[52:67]
    v_cvt_pk_bf16_f32 v69, v38, v39
    v_exp_f32 v44, v44
    v_exp_f32 v45, v45
    v_cvt_pk_bf16_f32 v70, v40, v41
    v_exp_f32 v46, v46
    v_exp_f32 v47, v47
    v_cvt_pk_bf16_f32 v71, v42, v43
    v_mfma_f32_32x32x16_bf16 v[20:35], v[116:119], v[80:83], v[20:35]
    s_waitcnt lgkmcnt(2)
    ds_read_b128 v[116:119], v131 offset:21504
    v_exp_f32 v48, v48
    v_exp_f32 v49, v49
    v_cvt_pk_bf16_f32 v72, v44, v45
    v_exp_f32 v50, v50
    v_exp_f32 v51, v51
    v_cvt_pk_bf16_f32 v73, v46, v47
    v_exp_f32 v52, v52
    v_mfma_f32_32x32x16_bf16 v[4:19], v[120:123], v[68:71], v[4:19]
    v_exp_f32 v53, v53
    v_cvt_pk_bf16_f32 v74, v48, v49
    v_exp_f32 v54, v54
    v_exp_f32 v55, v55
    v_cvt_pk_bf16_f32 v75, v50, v51
    v_exp_f32 v56, v56
    v_mfma_f32_32x32x16_bf16 v[36:51], v[96:99], v[84:87], 0
    v_exp_f32 v57, v57
    v_cvt_pk_bf16_f32 v76, v52, v53
    v_exp_f32 v58, v58
    v_exp_f32 v59, v59
    v_mfma_f32_32x32x8bf16_1k v[36:51], v[104:105], v[92:93], v[36:51]
    v_cvt_pk_bf16_f32 v77, v54, v55
    v_exp_f32 v60, v60
    v_exp_f32 v61, v61
    v_cvt_pk_bf16_f32 v78, v56, v57
    v_exp_f32 v62, v62
    v_exp_f32 v63, v63
    v_cvt_pk_bf16_f32 v79, v58, v59
    v_mfma_f32_32x32x16_bf16 v[4:19], v[124:127], v[72:75], v[4:19]
    v_exp_f32 v64, v64
    v_exp_f32 v65, v65
    v_cvt_pk_bf16_f32 v80, v60, v61
    v_exp_f32 v66, v66
    v_exp_f32 v67, v67
    v_cvt_pk_bf16_f32 v81, v62, v63
    v_exp_f32 v36, v36
    v_mfma_f32_32x32x16_bf16 v[20:35], v[120:123], v[76:79], v[20:35]
    ds_read_b128 v[120:123], v132 offset:21504
    v_exp_f32 v37, v37
    v_cvt_pk_bf16_f32 v82, v64, v65
    v_exp_f32 v38, v38
    v_exp_f32 v39, v39
    v_cvt_pk_bf16_f32 v83, v66, v67
    v_exp_f32 v40, v40
    v_mfma_f32_32x32x16_bf16 v[52:67], v[96:99], v[88:91], 0
    ds_read_b128 v[96:99], v128 offset:26752
    v_exp_f32 v41, v41
    v_cvt_pk_bf16_f32 v68, v36, v37
    v_exp_f32 v42, v42
    v_exp_f32 v43, v43
    v_mfma_f32_32x32x8bf16_1k v[52:67], v[104:105], v[94:95], v[52:67]
    v_cvt_pk_bf16_f32 v69, v38, v39
    v_exp_f32 v44, v44
    v_exp_f32 v45, v45
    v_cvt_pk_bf16_f32 v70, v40, v41
    v_exp_f32 v46, v46
    v_exp_f32 v47, v47
    v_cvt_pk_bf16_f32 v71, v42, v43
    v_mfma_f32_32x32x16_bf16 v[20:35], v[124:127], v[80:83], v[20:35]
    s_waitcnt lgkmcnt(2)
    ds_read_b128 v[124:127], v133 offset:21504
    v_exp_f32 v48, v48
    v_exp_f32 v49, v49
    v_cvt_pk_bf16_f32 v72, v44, v45
    v_exp_f32 v50, v50
    v_exp_f32 v51, v51
    v_cvt_pk_bf16_f32 v73, v46, v47
    v_exp_f32 v52, v52
    v_mfma_f32_32x32x16_bf16 v[4:19], v[112:115], v[68:71], v[4:19]
    ds_read_b128 v[108:111], v129 offset:28800
    v_exp_f32 v53, v53
    v_cvt_pk_bf16_f32 v74, v48, v49
    v_exp_f32 v54, v54
    v_exp_f32 v55, v55
    v_cvt_pk_bf16_f32 v75, v50, v51
    v_exp_f32 v56, v56
    v_mfma_f32_32x32x16_bf16 v[36:51], v[100:103], v[84:87], 0
    v_exp_f32 v57, v57
    v_cvt_pk_bf16_f32 v76, v52, v53
    v_exp_f32 v58, v58
    v_exp_f32 v59, v59
    v_mfma_f32_32x32x8bf16_1k v[36:51], v[106:107], v[92:93], v[36:51]
    v_cvt_pk_bf16_f32 v77, v54, v55
    v_exp_f32 v60, v60
    v_exp_f32 v61, v61
    v_cvt_pk_bf16_f32 v78, v56, v57
    v_exp_f32 v62, v62
    v_exp_f32 v63, v63
    v_cvt_pk_bf16_f32 v79, v58, v59
    v_mfma_f32_32x32x16_bf16 v[4:19], v[116:119], v[72:75], v[4:19]
    v_exp_f32 v64, v64
    v_exp_f32 v65, v65
    v_cvt_pk_bf16_f32 v80, v60, v61
    v_exp_f32 v66, v66
    v_exp_f32 v67, v67
    v_cvt_pk_bf16_f32 v81, v62, v63
    v_exp_f32 v36, v36
    v_mfma_f32_32x32x16_bf16 v[20:35], v[112:115], v[76:79], v[20:35]
    ds_read_b128 v[112:115], v130 offset:26752
    v_exp_f32 v37, v37
    v_cvt_pk_bf16_f32 v82, v64, v65
    v_exp_f32 v38, v38
    v_exp_f32 v39, v39
    v_cvt_pk_bf16_f32 v83, v66, v67
    v_exp_f32 v40, v40
    v_mfma_f32_32x32x16_bf16 v[52:67], v[100:103], v[88:91], 0
    ds_read_b128 v[100:103], v128 offset:27776
    v_exp_f32 v41, v41
    v_cvt_pk_bf16_f32 v68, v36, v37
    v_exp_f32 v42, v42
    v_exp_f32 v43, v43
    v_mfma_f32_32x32x8bf16_1k v[52:67], v[106:107], v[94:95], v[52:67]
    v_cvt_pk_bf16_f32 v69, v38, v39
    v_exp_f32 v44, v44
    v_exp_f32 v45, v45
    v_cvt_pk_bf16_f32 v70, v40, v41
    v_exp_f32 v46, v46
    v_exp_f32 v47, v47
    v_cvt_pk_bf16_f32 v71, v42, v43
    v_mfma_f32_32x32x16_bf16 v[20:35], v[116:119], v[80:83], v[20:35]
    s_waitcnt lgkmcnt(2)
    ds_read_b128 v[116:119], v131 offset:26752
    v_exp_f32 v48, v48
    v_exp_f32 v49, v49
    v_cvt_pk_bf16_f32 v72, v44, v45
    v_exp_f32 v50, v50
    v_exp_f32 v51, v51
    v_cvt_pk_bf16_f32 v73, v46, v47
    v_exp_f32 v52, v52
    v_mfma_f32_32x32x16_bf16 v[4:19], v[120:123], v[68:71], v[4:19]
    ds_read_b32 v143, v145
    v_exp_f32 v53, v53
    v_cvt_pk_bf16_f32 v74, v48, v49
    v_exp_f32 v54, v54
    v_exp_f32 v55, v55
    v_cvt_pk_bf16_f32 v75, v50, v51
    v_exp_f32 v56, v56
    v_mfma_f32_32x32x16_bf16 v[36:51], v[96:99], v[84:87], 0
    ds_write_b32 v146, v144
    v_exp_f32 v57, v57
    v_cvt_pk_bf16_f32 v76, v52, v53
    v_exp_f32 v58, v58
    v_exp_f32 v59, v59
    v_mfma_f32_32x32x8bf16_1k v[36:51], v[108:109], v[92:93], v[36:51]
    v_cvt_pk_bf16_f32 v77, v54, v55
    v_exp_f32 v60, v60
    v_exp_f32 v61, v61
    v_cvt_pk_bf16_f32 v78, v56, v57
    v_exp_f32 v62, v62
    v_exp_f32 v63, v63
    v_cvt_pk_bf16_f32 v79, v58, v59
    v_mfma_f32_32x32x16_bf16 v[4:19], v[124:127], v[72:75], v[4:19]
    s_waitcnt lgkmcnt(0)
    v_exp_f32 v64, v64
    v_exp_f32 v65, v65
    v_readfirstlane_b32 s62, v143
    v_cvt_pk_bf16_f32 v80, v60, v61
    v_exp_f32 v66, v66
    v_exp_f32 v67, v67
    v_cvt_pk_bf16_f32 v81, v62, v63
    v_exp_f32 v36, v36
    v_mfma_f32_32x32x16_bf16 v[20:35], v[120:123], v[76:79], v[20:35]
    s_cmp_ge_u32 s62, s61
    ds_read_b128 v[120:123], v132 offset:26752
    v_exp_f32 v37, v37
    v_cvt_pk_bf16_f32 v82, v64, v65
    s_cbranch_scc0 k2_wait3
k2_go3:
    v_exp_f32 v38, v38
    v_exp_f32 v39, v39
    v_cvt_pk_bf16_f32 v83, v66, v67
    v_exp_f32 v40, v40
    v_mfma_f32_32x32x16_bf16 v[52:67], v[96:99], v[88:91], 0
    s_add_u32 s61, s61, 2
    ds_read_b128 v[96:99], v134 offset:0
    v_exp_f32 v41, v41
    v_cvt_pk_bf16_f32 v68, v36, v37
    v_exp_f32 v42, v42
    v_exp_f32 v43, v43
    v_mfma_f32_32x32x8bf16_1k v[52:67], v[108:109], v[94:95], v[52:67]
    v_cvt_pk_bf16_f32 v69, v38, v39
    v_exp_f32 v44, v44
    v_exp_f32 v45, v45
    v_cvt_pk_bf16_f32 v70, v40, v41
    v_exp_f32 v46, v46
    v_exp_f32 v47, v47
    v_cvt_pk_bf16_f32 v71, v42, v43
    v_mfma_f32_32x32x16_bf16 v[20:35], v[124:127], v[80:83], v[20:35]
    s_waitcnt lgkmcnt(2)
    ds_read_b128 v[124:127], v133 offset:26752
    v_exp_f32 v48, v48
    v_exp_f32 v49, v49
    v_cvt_pk_bf16_f32 v72, v44, v45
    v_exp_f32 v50, v50
    v_exp_f32 v51, v51
    v_cvt_pk_bf16_f32 v73, v46, v47
    v_exp_f32 v52, v52
    v_mfma_f32_32x32x16_bf16 v[4:19], v[112:115], v[68:71], v[4:19]
    ds_read_b128 v[104:107], v135 offset:2048
    v_exp_f32 v53, v53
    v_cvt_pk_bf16_f32 v74, v48, v49
    v_exp_f32 v54, v54
    v_exp_f32 v55, v55
    v_cvt_pk_bf16_f32 v75, v50, v51
    v_exp_f32 v56, v56
    v_mfma_f32_32x32x16_bf16 v[36:51], v[100:103], v[84:87], 0
    v_exp_f32 v57, v57
    v_cvt_pk_bf16_f32 v76, v52, v53
    v_add_u32 v144, 1, v144
    v_exp_f32 v58, v58
    v_exp_f32 v59, v59
    v_mfma_f32_32x32x8bf16_1k v[36:51], v[110:111], v[92:93], v[36:51]
    v_cvt_pk_bf16_f32 v77, v54, v55
    v_exp_f32 v60, v60
    v_exp_f32 v61, v61
    v_cvt_pk_bf16_f32 v78, v56, v57
    v_exp_f32 v62, v62
    v_exp_f32 v63, v63
    v_cvt_pk_bf16_f32 v79, v58, v59
    v_mfma_f32_32x32x16_bf16 v[4:19], v[116:119], v[72:75], v[4:19]
    v_exp_f32 v64, v64
    v_exp_f32 v65, v65
    v_cvt_pk_bf16_f32 v80, v60, v61
    v_exp_f32 v66, v66
    v_exp_f32 v67, v67
    v_cvt_pk_bf16_f32 v81, v62, v63
    v_exp_f32 v36, v36
    v_mfma_f32_32x32x16_bf16 v[20:35], v[112:115], v[76:79], v[20:35]
    ds_read_b128 v[112:115], v136 offset:0
    v_exp_f32 v37, v37
    v_cvt_pk_bf16_f32 v82, v64, v65
    v_exp_f32 v38, v38
    v_exp_f32 v39, v39
    v_cvt_pk_bf16_f32 v83, v66, v67
    v_exp_f32 v40, v40
    v_mfma_f32_32x32x16_bf16 v[52:67], v[100:103], v[88:91], 0
    ds_read_b128 v[100:103], v134 offset:1024
    v_exp_f32 v41, v41
    v_cvt_pk_bf16_f32 v68, v36, v37
    v_exp_f32 v42, v42
    v_exp_f32 v43, v43
    v_mfma_f32_32x32x8bf16_1k v[52:67], v[110:111], v[94:95], v[52:67]
    v_cvt_pk_bf16_f32 v69, v38, v39
    v_exp_f32 v44, v44
    v_exp_f32 v45, v45
    v_cvt_pk_bf16_f32 v70, v40, v41
    v_exp_f32 v46, v46
    v_exp_f32 v47, v47
    v_cvt_pk_bf16_f32 v71, v42, v43
    v_mfma_f32_32x32x16_bf16 v[20:35], v[116:119], v[80:83], v[20:35]
    s_waitcnt lgkmcnt(2)
    ds_read_b128 v[116:119], v137 offset:0
    v_exp_f32 v48, v48
    v_exp_f32 v49, v49
    v_cvt_pk_bf16_f32 v72, v44, v45
    v_exp_f32 v50, v50
    v_exp_f32 v51, v51
    v_cvt_pk_bf16_f32 v73, v46, v47
    v_exp_f32 v52, v52
    v_mfma_f32_32x32x16_bf16 v[4:19], v[120:123], v[68:71], v[4:19]
    v_exp_f32 v53, v53
    v_cvt_pk_bf16_f32 v74, v48, v49
    v_exp_f32 v54, v54
    v_exp_f32 v55, v55
    v_cvt_pk_bf16_f32 v75, v50, v51
    v_exp_f32 v56, v56
    v_mfma_f32_32x32x16_bf16 v[36:51], v[96:99], v[84:87], 0
    v_exp_f32 v57, v57
    v_cvt_pk_bf16_f32 v76, v52, v53
    v_exp_f32 v58, v58
    v_exp_f32 v59, v59
    v_mfma_f32_32x32x8bf16_1k v[36:51], v[104:105], v[92:93], v[36:51]
    v_cvt_pk_bf16_f32 v77, v54, v55
    v_exp_f32 v60, v60
    v_exp_f32 v61, v61
    v_cvt_pk_bf16_f32 v78, v56, v57
    v_exp_f32 v62, v62
    v_exp_f32 v63, v63
    v_cvt_pk_bf16_f32 v79, v58, v59
    v_mfma_f32_32x32x16_bf16 v[4:19], v[124:127], v[72:75], v[4:19]
    v_exp_f32 v64, v64
    v_exp_f32 v65, v65
    v_cvt_pk_bf16_f32 v80, v60, v61
    v_exp_f32 v66, v66
    v_exp_f32 v67, v67
    v_cvt_pk_bf16_f32 v81, v62, v63
    v_exp_f32 v36, v36
    v_mfma_f32_32x32x16_bf16 v[20:35], v[120:123], v[76:79], v[20:35]
    ds_read_b128 v[120:123], v138 offset:0
    v_exp_f32 v37, v37
    v_cvt_pk_bf16_f32 v82, v64, v65
    v_exp_f32 v38, v38
    v_exp_f32 v39, v39
    v_cvt_pk_bf16_f32 v83, v66, v67
    v_exp_f32 v40, v40
    v_mfma_f32_32x32x16_bf16 v[52:67], v[96:99], v[88:91], 0
    ds_read_b128 v[96:99], v134 offset:5248
    v_exp_f32 v41, v41
    v_cvt_pk_bf16_f32 v68, v36, v37
    v_exp_f32 v42, v42
    v_exp_f32 v43, v43
    v_mfma_f32_32x32x8bf16_1k v[52:67], v[104:105], v[94:95], v[52:67]
    v_cvt_pk_bf16_f32 v69, v38, v39
    v_exp_f32 v44, v44
    v_exp_f32 v45, v45
    v_cvt_pk_bf16_f32 v70, v40, v41
    v_exp_f32 v46, v46
    v_exp_f32 v47, v47
    v_cvt_pk_bf16_f32 v71, v42, v43
    v_mfma_f32_32x32x16_bf16 v[20:35], v[124:127], v[80:83], v[20:35]
    s_waitcnt lgkmcnt(2)
    ds_read_b128 v[124:127], v139 offset:0
    v_exp_f32 v48, v48
    v_exp_f32 v49, v49
    v_cvt_pk_bf16_f32 v72, v44, v45
    v_exp_f32 v50, v50
    v_exp_f32 v51, v51
    v_cvt_pk_bf16_f32 v73, v46, v47
    v_exp_f32 v52, v52
    v_mfma_f32_32x32x16_bf16 v[4:19], v[112:115], v[68:71], v[4:19]
    ds_read_b128 v[108:111], v135 offset:7296
    v_exp_f32 v53, v53
    v_cvt_pk_bf16_f32 v74, v48, v49
    v_exp_f32 v54, v54
    v_exp_f32 v55, v55
    v_cvt_pk_bf16_f32 v75, v50, v51
    v_exp_f32 v56, v56
    v_mfma_f32_32x32x16_bf16 v[36:51], v[100:103], v[84:87], 0
    v_exp_f32 v57, v57
    v_cvt_pk_bf16_f32 v76, v52, v53
    v_exp_f32 v58, v58
    v_exp_f32 v59, v59
    v_mfma_f32_32x32x8bf16_1k v[36:51], v[106:107], v[92:93], v[36:51]
    v_cvt_pk_bf16_f32 v77, v54, v55
    v_exp_f32 v60, v60
    v_exp_f32 v61, v61
    v_cvt_pk_bf16_f32 v78, v56, v57
    v_exp_f32 v62, v62
    v_exp_f32 v63, v63
    v_cvt_pk_bf16_f32 v79, v58, v59
    v_mfma_f32_32x32x16_bf16 v[4:19], v[116:119], v[72:75], v[4:19]
    v_exp_f32 v64, v64
    v_exp_f32 v65, v65
    v_cvt_pk_bf16_f32 v80, v60, v61
    v_exp_f32 v66, v66
    v_exp_f32 v67, v67
    v_cvt_pk_bf16_f32 v81, v62, v63
    v_exp_f32 v36, v36
    v_mfma_f32_32x32x16_bf16 v[20:35], v[112:115], v[76:79], v[20:35]
    ds_read_b128 v[112:115], v136 offset:5248
    v_exp_f32 v37, v37
    v_cvt_pk_bf16_f32 v82, v64, v65
    v_exp_f32 v38, v38
    v_exp_f32 v39, v39
    v_cvt_pk_bf16_f32 v83, v66, v67
    v_exp_f32 v40, v40
    v_mfma_f32_32x32x16_bf16 v[52:67], v[100:103], v[88:91], 0
    ds_read_b128 v[100:103], v134 offset:6272
    v_exp_f32 v41, v41
    v_cvt_pk_bf16_f32 v68, v36, v37
    v_exp_f32 v42, v42
    v_exp_f32 v43, v43
    v_mfma_f32_32x32x8bf16_1k v[52:67], v[106:107], v[94:95], v[52:67]
    v_cvt_pk_bf16_f32 v69, v38, v39
    v_exp_f32 v44, v44
    v_exp_f32 v45, v45
    v_cvt_pk_bf16_f32 v70, v40, v41
    v_exp_f32 v46, v46
    v_exp_f32 v47, v47
    v_cvt_pk_bf16_f32 v71, v42, v43
    v_mfma_f32_32x32x16_bf16 v[20:35], v[116:119], v[80:83], v[20:35]
    s_waitcnt lgkmcnt(2)
    ds_read_b128 v[116:119], v137 offset:5248
    v_exp_f32 v48, v48
    v_exp_f32 v49, v49
    v_cvt_pk_bf16_f32 v72, v44, v45
    v_exp_f32 v50, v50
    v_exp_f32 v51, v51
    v_cvt_pk_bf16_f32 v73, v46, v47
    v_exp_f32 v52, v52
    v_mfma_f32_32x32x16_bf16 v[4:19], v[120:123], v[68:71], v[4:19]
    v_exp_f32 v53, v53
    v_cvt_pk_bf16_f32 v74, v48, v49
    v_exp_f32 v54, v54
    v_exp_f32 v55, v55
    v_cvt_pk_bf16_f32 v75, v50, v51
    v_exp_f32 v56, v56
    v_mfma_f32_32x32x16_bf16 v[36:51], v[96:99], v[84:87], 0
    ds_write_b32 v146, v144
    v_exp_f32 v57, v57
    v_cvt_pk_bf16_f32 v76, v52, v53
    v_exp_f32 v58, v58
    v_exp_f32 v59, v59
    v_mfma_f32_32x32x8bf16_1k v[36:51], v[108:109], v[92:93], v[36:51]
    v_cvt_pk_bf16_f32 v77, v54, v55
    v_exp_f32 v60, v60
    v_exp_f32 v61, v61
    v_cvt_pk_bf16_f32 v78, v56, v57
    v_exp_f32 v62, v62
    v_exp_f32 v63, v63
    v_cvt_pk_bf16_f32 v79, v58, v59
    v_mfma_f32_32x32x16_bf16 v[4:19], v[124:127], v[72:75], v[4:19]
    v_exp_f32 v64, v64
    v_exp_f32 v65, v65
    v_cvt_pk_bf16_f32 v80, v60, v61
    v_exp_f32 v66, v66
    v_exp_f32 v67, v67
    v_cvt_pk_bf16_f32 v81, v62, v63
    v_exp_f32 v36, v36
    v_mfma_f32_32x32x16_bf16 v[20:35], v[120:123], v[76:79], v[20:35]
    ds_read_b128 v[120:123], v138 offset:5248
    v_exp_f32 v37, v37
    v_cvt_pk_bf16_f32 v82, v64, v65
    v_exp_f32 v38, v38
    v_exp_f32 v39, v39
    v_cvt_pk_bf16_f32 v83, v66, v67
    v_exp_f32 v40, v40
    v_mfma_f32_32x32x16_bf16 v[52:67], v[96:99], v[88:91], 0
    ds_read_b128 v[96:99], v134 offset:21504
    v_exp_f32 v41, v41
    v_cvt_pk_bf16_f32 v68, v36, v37
    v_exp_f32 v42, v42
    v_exp_f32 v43, v43
    v_mfma_f32_32x32x8bf16_1k v[52:67], v[108:109], v[94:95], v[52:67]
    v_cvt_pk_bf16_f32 v69, v38, v39
    v_exp_f32 v44, v44
    v_exp_f32 v45, v45
    v_cvt_pk_bf16_f32 v70, v40, v41
    v_exp_f32 v46, v46
    v_exp_f32 v47, v47
    v_cvt_pk_bf16_f32 v71, v42, v43
    v_mfma_f32_32x32x16_bf16 v[20:35], v[124:127], v[80:83], v[20:35]
    s_waitcnt lgkmcnt(2)
    ds_read_b128 v[124:127], v139 offset:5248
    v_exp_f32 v48, v48
    v_exp_f32 v49, v49
    v_cvt_pk_bf16_f32 v72, v44, v45
    v_exp_f32 v50, v50
    v_exp_f32 v51, v51
    v_cvt_pk_bf16_f32 v73, v46, v47
    v_exp_f32 v52, v52
    v_mfma_f32_32x32x16_bf16 v[4:19], v[112:115], v[68:71], v[4:19]
    ds_read_b128 v[104:107], v135 offset:23552
    v_exp_f32 v53, v53
    v_cvt_pk_bf16_f32 v74, v48, v49
    v_exp_f32 v54, v54
    v_exp_f32 v55, v55
    v_cvt_pk_bf16_f32 v75, v50, v51
    v_exp_f32 v56, v56
    v_mfma_f32_32x32x16_bf16 v[36:51], v[100:103], v[84:87], 0
    v_exp_f32 v57, v57
    v_cvt_pk_bf16_f32 v76, v52, v53
    v_add_u32 v144, 1, v144
    v_exp_f32 v58, v58
    v_exp_f32 v59, v59
    v_mfma_f32_32x32x8bf16_1k v[36:51], v[110:111], v[92:93], v[36:51]
    v_cvt_pk_bf16_f32 v77, v54, v55
    v_exp_f32 v60, v60
    v_exp_f32 v61, v61
    v_cvt_pk_bf16_f32 v78, v56, v57
    v_exp_f32 v62, v62
    v_exp_f32 v63, v63
    v_cvt_pk_bf16_f32 v79, v58, v59
    v_mfma_f32_32x32x16_bf16 v[4:19], v[116:119], v[72:75], v[4:19]
    v_exp_f32 v64, v64
    v_exp_f32 v65, v65
    v_cvt_pk_bf16_f32 v80, v60, v61
    v_exp_f32 v66, v66
    v_exp_f32 v67, v67
    v_cvt_pk_bf16_f32 v81, v62, v63
    v_exp_f32 v36, v36
    v_mfma_f32_32x32x16_bf16 v[20:35], v[112:115], v[76:79], v[20:35]
    ds_read_b128 v[112:115], v136 offset:21504
    v_exp_f32 v37, v37
    v_cvt_pk_bf16_f32 v82, v64, v65
    v_exp_f32 v38, v38
    v_exp_f32 v39, v39
    v_cvt_pk_bf16_f32 v83, v66, v67
    v_exp_f32 v40, v40
    v_mfma_f32_32x32x16_bf16 v[52:67], v[100:103], v[88:91], 0
    ds_read_b128 v[100:103], v134 offset:22528
    v_exp_f32 v41, v41
    v_cvt_pk_bf16_f32 v68, v36, v37
    v_exp_f32 v42, v42
    v_exp_f32 v43, v43
    v_mfma_f32_32x32x8bf16_1k v[52:67], v[110:111], v[94:95], v[52:67]
    v_cvt_pk_bf16_f32 v69, v38, v39
    v_exp_f32 v44, v44
    v_exp_f32 v45, v45
    v_cvt_pk_bf16_f32 v70, v40, v41
    v_exp_f32 v46, v46
    v_exp_f32 v47, v47
    v_cvt_pk_bf16_f32 v71, v42, v43
    v_mfma_f32_32x32x16_bf16 v[20:35], v[116:119], v[80:83], v[20:35]
    s_waitcnt lgkmcnt(2)
    ds_read_b128 v[116:119], v137 offset:21504
    v_exp_f32 v48, v48
    v_exp_f32 v49, v49
    v_cvt_pk_bf16_f32 v72, v44, v45
    v_exp_f32 v50, v50
    v_exp_f32 v51, v51
    v_cvt_pk_bf16_f32 v73, v46, v47
    v_exp_f32 v52, v52
    v_mfma_f32_32x32x16_bf16 v[4:19], v[120:123], v[68:71], v[4:19]
    v_exp_f32 v53, v53
    v_cvt_pk_bf16_f32 v74, v48, v49
    v_exp_f32 v54, v54
    v_exp_f32 v55, v55
    v_cvt_pk_bf16_f32 v75, v50, v51
    v_exp_f32 v56, v56
    v_mfma_f32_32x32x16_bf16 v[36:51], v[96:99], v[84:87], 0
    v_exp_f32 v57, v57
    v_cvt_pk_bf16_f32 v76, v52, v53
    v_exp_f32 v58, v58
    v_exp_f32 v59, v59
    v_mfma_f32_32x32x8bf16_1k v[36:51], v[104:105], v[92:93], v[36:51]
    v_cvt_pk_bf16_f32 v77, v54, v55
    v_exp_f32 v60, v60
    v_exp_f32 v61, v61
    v_cvt_pk_bf16_f32 v78, v56, v57
    v_exp_f32 v62, v62
    v_exp_f32 v63, v63
    v_cvt_pk_bf16_f32 v79, v58, v59
    v_mfma_f32_32x32x16_bf16 v[4:19], v[124:127], v[72:75], v[4:19]
    v_exp_f32 v64, v64
    v_exp_f32 v65, v65
    v_cvt_pk_bf16_f32 v80, v60, v61
    v_exp_f32 v66, v66
    v_exp_f32 v67, v67
    v_cvt_pk_bf16_f32 v81, v62, v63
    v_exp_f32 v36, v36
    v_mfma_f32_32x32x16_bf16 v[20:35], v[120:123], v[76:79], v[20:35]
    ds_read_b128 v[120:123], v138 offset:21504
    v_exp_f32 v37, v37
    v_cvt_pk_bf16_f32 v82, v64, v65
    v_exp_f32 v38, v38
    v_exp_f32 v39, v39
    v_cvt_pk_bf16_f32 v83, v66, v67
    v_exp_f32 v40, v40
    v_mfma_f32_32x32x16_bf16 v[52:67], v[96:99], v[88:91], 0
    ds_read_b128 v[96:99], v134 offset:26752
    v_exp_f32 v41, v41
    v_cvt_pk_bf16_f32 v68, v36, v37
    v_exp_f32 v42, v42
    v_exp_f32 v43, v43
    v_mfma_f32_32x32x8bf16_1k v[52:67], v[104:105], v[94:95], v[52:67]
    v_cvt_pk_bf16_f32 v69, v38, v39
    v_exp_f32 v44, v44
    v_exp_f32 v45, v45
    v_cvt_pk_bf16_f32 v70, v40, v41
    v_exp_f32 v46, v46
    v_exp_f32 v47, v47
    v_cvt_pk_bf16_f32 v71, v42, v43
    v_mfma_f32_32x32x16_bf16 v[20:35], v[124:127], v[80:83], v[20:35]
    s_waitcnt lgkmcnt(2)
    ds_read_b128 v[124:127], v139 offset:21504
    v_exp_f32 v48, v48
    v_exp_f32 v49, v49
    v_cvt_pk_bf16_f32 v72, v44, v45
    v_exp_f32 v50, v50
    v_exp_f32 v51, v51
    v_cvt_pk_bf16_f32 v73, v46, v47
    v_exp_f32 v52, v52
    v_mfma_f32_32x32x16_bf16 v[4:19], v[112:115], v[68:71], v[4:19]
    ds_read_b128 v[108:111], v135 offset:28800
    v_exp_f32 v53, v53
    v_cvt_pk_bf16_f32 v74, v48, v49
    v_exp_f32 v54, v54
    v_exp_f32 v55, v55
    v_cvt_pk_bf16_f32 v75, v50, v51
    v_exp_f32 v56, v56
    v_mfma_f32_32x32x16_bf16 v[36:51], v[100:103], v[84:87], 0
    v_exp_f32 v57, v57
    v_cvt_pk_bf16_f32 v76, v52, v53
    v_exp_f32 v58, v58
    v_exp_f32 v59, v59
    v_mfma_f32_32x32x8bf16_1k v[36:51], v[106:107], v[92:93], v[36:51]
    v_cvt_pk_bf16_f32 v77, v54, v55
    v_exp_f32 v60, v60
    v_exp_f32 v61, v61
    v_cvt_pk_bf16_f32 v78, v56, v57
    v_exp_f32 v62, v62
    v_exp_f32 v63, v63
    v_cvt_pk_bf16_f32 v79, v58, v59
    v_mfma_f32_32x32x16_bf16 v[4:19], v[116:119], v[72:75], v[4:19]
    v_exp_f32 v64, v64
    v_exp_f32 v65, v65
    v_cvt_pk_bf16_f32 v80, v60, v61
    v_exp_f32 v66, v66
    v_exp_f32 v67, v67
    v_cvt_pk_bf16_f32 v81, v62, v63
    v_exp_f32 v36, v36
    v_mfma_f32_32x32x16_bf16 v[20:35], v[112:115], v[76:79], v[20:35]
    ds_read_b128 v[112:115], v136 offset:26752
    v_exp_f32 v37, v37
    v_cvt_pk_bf16_f32 v82, v64, v65
    v_exp_f32 v38, v38
    v_exp_f32 v39, v39
    v_cvt_pk_bf16_f32 v83, v66, v67
    v_exp_f32 v40, v40
    v_mfma_f32_32x32x16_bf16 v[52:67], v[100:103], v[88:91], 0
    ds_read_b128 v[100:103], v134 offset:27776
    v_exp_f32 v41, v41
    v_cvt_pk_bf16_f32 v68, v36, v37
    v_exp_f32 v42, v42
    v_exp_f32 v43, v43
    v_mfma_f32_32x32x8bf16_1k v[52:67], v[106:107], v[94:95], v[52:67]
    v_cvt_pk_bf16_f32 v69, v38, v39
    v_exp_f32 v44, v44
    v_exp_f32 v45, v45
    v_cvt_pk_bf16_f32 v70, v40, v41
    v_exp_f32 v46, v46
    v_exp_f32 v47, v47
    v_cvt_pk_bf16_f32 v71, v42, v43
    v_mfma_f32_32x32x16_bf16 v[20:35], v[116:119], v[80:83], v[20:35]
    s_waitcnt lgkmcnt(2)
    ds_read_b128 v[116:119], v137 offset:26752
    v_exp_f32 v48, v48
    v_exp_f32 v49, v49
    v_cvt_pk_bf16_f32 v72, v44, v45
    v_exp_f32 v50, v50
    v_exp_f32 v51, v51
    v_cvt_pk_bf16_f32 v73, v46, v47
    v_exp_f32 v52, v52
    v_mfma_f32_32x32x16_bf16 v[4:19], v[120:123], v[68:71], v[4:19]
    ds_read_b32 v143, v145
    v_exp_f32 v53, v53
    v_cvt_pk_bf16_f32 v74, v48, v49
    v_exp_f32 v54, v54
    v_exp_f32 v55, v55
    v_cvt_pk_bf16_f32 v75, v50, v51
    v_exp_f32 v56, v56
    v_mfma_f32_32x32x16_bf16 v[36:51], v[96:99], v[84:87], 0
    ds_write_b32 v146, v144
    v_exp_f32 v57, v57
    v_cvt_pk_bf16_f32 v76, v52, v53
    v_exp_f32 v58, v58
    v_exp_f32 v59, v59
    v_mfma_f32_32x32x8bf16_1k v[36:51], v[108:109], v[92:93], v[36:51]
    v_cvt_pk_bf16_f32 v77, v54, v55
    v_exp_f32 v60, v60
    v_exp_f32 v61, v61
    v_cvt_pk_bf16_f32 v78, v56, v57
    v_exp_f32 v62, v62
    v_exp_f32 v63, v63
    v_cvt_pk_bf16_f32 v79, v58, v59
    v_mfma_f32_32x32x16_bf16 v[4:19], v[124:127], v[72:75], v[4:19]
    s_waitcnt lgkmcnt(0)
    v_exp_f32 v64, v64
    v_exp_f32 v65, v65
    v_readfirstlane_b32 s62, v143
    v_cvt_pk_bf16_f32 v80, v60, v61
    v_exp_f32 v66, v66
    v_exp_f32 v67, v67
    v_cvt_pk_bf16_f32 v81, v62, v63
    v_exp_f32 v36, v36
    v_mfma_f32_32x32x16_bf16 v[20:35], v[120:123], v[76:79], v[20:35]
    s_cmp_ge_u32 s62, s61
    ds_read_b128 v[120:123], v138 offset:26752
    v_exp_f32 v37, v37
    v_cvt_pk_bf16_f32 v82, v64, v65
    s_cbranch_scc0 k2_wait7
k2_go7:
    v_exp_f32 v38, v38
    v_exp_f32 v39, v39
    v_cvt_pk_bf16_f32 v83, v66, v67
    v_exp_f32 v40, v40
    v_mfma_f32_32x32x16_bf16 v[52:67], v[96:99], v[88:91], 0
    s_add_u32 s61, s61, 2
    ds_read_b128 v[96:99], v128 offset:0
    v_exp_f32 v41, v41
    v_cvt_pk_bf16_f32 v68, v36, v37
    v_exp_f32 v42, v42
    v_exp_f32 v43, v43
    v_mfma_f32_32x32x8bf16_1k v[52:67], v[108:109], v[94:95], v[52:67]
    v_cvt_pk_bf16_f32 v69, v38, v39
    v_exp_f32 v44, v44
    v_exp_f32 v45, v45
    v_cvt_pk_bf16_f32 v70, v40, v41
    v_exp_f32 v46, v46
    v_exp_f32 v47, v47
    v_cvt_pk_bf16_f32 v71, v42, v43
    v_mfma_f32_32x32x16_bf16 v[20:35], v[124:127], v[80:83], v[20:35]
    s_waitcnt lgkmcnt(2)
    ds_read_b128 v[124:127], v139 offset:26752
    v_exp_f32 v48, v48
    v_exp_f32 v49, v49
    v_cvt_pk_bf16_f32 v72, v44, v45
    v_exp_f32 v50, v50
    v_exp_f32 v51, v51
    v_cvt_pk_bf16_f32 v73, v46, v47
    v_exp_f32 v52, v52
    v_mfma_f32_32x32x16_bf16 v[4:19], v[112:115], v[68:71], v[4:19]
    ds_read_b128 v[104:107], v129 offset:2048
    v_exp_f32 v53, v53
    v_cvt_pk_bf16_f32 v74, v48, v49
    v_exp_f32 v54, v54
    v_exp_f32 v55, v55
    v_cvt_pk_bf16_f32 v75, v50, v51
    v_exp_f32 v56, v56
    v_mfma_f32_32x32x16_bf16 v[36:51], v[100:103], v[84:87], 0
    v_exp_f32 v57, v57
    v_cvt_pk_bf16_f32 v76, v52, v53
    v_add_u32 v144, 1, v144
    v_exp_f32 v58, v58
    v_exp_f32 v59, v59
    v_mfma_f32_32x32x8bf16_1k v[36:51], v[110:111], v[92:93], v[36:51]
    v_cvt_pk_bf16_f32 v77, v54, v55
    v_exp_f32 v60, v60
    v_exp_f32 v61, v61
    v_cvt_pk_bf16_f32 v78, v56, v57
    v_exp_f32 v62, v62
    v_exp_f32 v63, v63
    v_cvt_pk_bf16_f32 v79, v58, v59
    v_mfma_f32_32x32x16_bf16 v[4:19], v[116:119], v[72:75], v[4:19]
    v_exp_f32 v64, v64
    v_exp_f32 v65, v65
    v_cvt_pk_bf16_f32 v80, v60, v61
    v_exp_f32 v66, v66
    v_exp_f32 v67, v67
    v_cvt_pk_bf16_f32 v81, v62, v63
    v_exp_f32 v36, v36
    v_mfma_f32_32x32x16_bf16 v[20:35], v[112:115], v[76:79], v[20:35]
    ds_read_b128 v[112:115], v130 offset:0
    v_exp_f32 v37, v37
    v_cvt_pk_bf16_f32 v82, v64, v65
    v_exp_f32 v38, v38
    v_exp_f32 v39, v39
    v_cvt_pk_bf16_f32 v83, v66, v67
    v_exp_f32 v40, v40
    v_mfma_f32_32x32x16_bf16 v[52:67], v[100:103], v[88:91], 0
    ds_read_b128 v[100:103], v128 offset:1024
    v_exp_f32 v41, v41
    v_cvt_pk_bf16_f32 v68, v36, v37
    v_exp_f32 v42, v42
    v_exp_f32 v43, v43
    v_mfma_f32_32x32x8bf16_1k v[52:67], v[110:111], v[94:95], v[52:67]
    v_cvt_pk_bf16_f32 v69, v38, v39
    v_exp_f32 v44, v44
    v_exp_f32 v45, v45
    v_cvt_pk_bf16_f32 v70, v40, v41
    v_exp_f32 v46, v46
    v_exp_f32 v47, v47
    v_cvt_pk_bf16_f32 v71, v42, v43
    v_mfma_f32_32x32x16_bf16 v[20:35], v[116:119], v[80:83], v[20:35]
    s_waitcnt lgkmcnt(2)
    ds_read_b128 v[116:119], v131 offset:0
    v_exp_f32 v48, v48
    v_exp_f32 v49, v49
    v_cvt_pk_bf16_f32 v72, v44, v45
    v_exp_f32 v50, v50
    v_exp_f32 v51, v51
    v_cvt_pk_bf16_f32 v73, v46, v47
    v_exp_f32 v52, v52
    v_mfma_f32_32x32x16_bf16 v[4:19], v[120:123], v[68:71], v[4:19]
    s_add_u32 s42, s42, 1
    v_exp_f32 v53, v53
    v_cvt_pk_bf16_f32 v74, v48, v49
    v_exp_f32 v54, v54
    v_exp_f32 v55, v55
    v_cvt_pk_bf16_f32 v75, v50, v51
    v_exp_f32 v56, v56
    v_mfma_f32_32x32x16_bf16 v[36:51], v[96:99], v[84:87], 0
    v_exp_f32 v57, v57
    v_cvt_pk_bf16_f32 v76, v52, v53
    v_exp_f32 v58, v58
    v_exp_f32 v59, v59
    v_mfma_f32_32x32x8bf16_1k v[36:51], v[104:105], v[92:93], v[36:51]
    v_cvt_pk_bf16_f32 v77, v54, v55
    v_exp_f32 v60, v60
    v_exp_f32 v61, v61
    v_cvt_pk_bf16_f32 v78, v56, v57
    v_exp_f32 v62, v62
    v_exp_f32 v63, v63
    v_cvt_pk_bf16_f32 v79, v58, v59
    v_mfma_f32_32x32x16_bf16 v[4:19], v[124:127], v[72:75], v[4:19]
    s_cmp_lt_u32 s42, 2
    v_exp_f32 v64, v64
    v_exp_f32 v65, v65
    v_cvt_pk_bf16_f32 v80, v60, v61
    v_exp_f32 v66, v66
    v_exp_f32 v67, v67
    v_cvt_pk_bf16_f32 v81, v62, v63
    s_cbranch_scc1 k2_loop
k2_exit:
    v_cvt_pk_bf16_f32 v82, v64, v65
    v_cvt_pk_bf16_f32 v83, v66, v67
    v_mfma_f32_32x32x16_bf16 v[20:35], v[120:123], v[76:79], v[20:35]
    s_nop 0
    v_mfma_f32_32x32x16_bf16 v[20:35], v[124:127], v[80:83], v[20:35]
    ds_write_b128 v147, v[4:7] offset:0
    ds_write_b128 v147, v[8:11] offset:1024
    ds_write_b128 v147, v[12:15] offset:2048
    ds_write_b32 v147, v16 offset:3072
    s_waitcnt lgkmcnt(0)
    s_barrier
    ds_read_b128 v[4:7], v148 offset:0
    ds_read_b128 v[8:11], v148 offset:1024
    ds_read_b128 v[12:15], v148 offset:2048
    ds_read_b32 v16, v148 offset:3072
    v_cmp_gt_u32 vcc, 32, v0
    s_waitcnt lgkmcnt(3)
    v_add_f32 v20, v20, v4
    v_add_f32 v21, v21, v5
    v_add_f32 v22, v22, v6
    v_add_f32 v23, v23, v7
    s_waitcnt lgkmcnt(2)
    v_add_f32 v24, v24, v8
    v_add_f32 v25, v25, v9
    v_add_f32 v26, v26, v10
    v_add_f32 v27, v27, v11
    s_waitcnt lgkmcnt(1)
    v_add_f32 v28, v28, v12
    v_add_f32 v29, v29, v13
    v_add_f32 v30, v30, v14
    v_add_f32 v31, v31, v15
    s_waitcnt lgkmcnt(0)
    v_add_f32 v32, v32, v16
    s_mov_b32 s48, 0x17800000
    s_mov_b32 s49, 0x71800000
    s_mov_b32 s59, 0x7f800000
    v_add_f32 v150, abs(v20), abs(v21)
    v_add_f32 v150, v150, abs(v22)
    v_add_f32 v150, v150, abs(v23)
    v_add_f32 v150, v150, abs(v24)
    v_add_f32 v150, v150, abs(v25)
    v_add_f32 v150, v150, abs(v26)
    v_add_f32 v150, v150, abs(v27)
    v_add_f32 v150, v150, abs(v28)
    v_add_f32 v150, v150, abs(v29)
    v_add_f32 v150, v150, abs(v30)
    v_add_f32 v150, v150, abs(v31)
    v_cndmask_b32 v149, v28, v32, vcc
    v_cmp_gt_f32 s[50:51], s59, v150
    v_cmp_le_f32 s[52:53], s48, v149
    v_cmp_ge_f32 vcc, s49, v149
    s_nop 1
    s_and_b64 s[50:51], s[50:51], s[52:53]
    s_and_b64 s[50:51], s[50:51], vcc
    s_cmp_eq_u64 s[50:51], -1
    s_cbranch_scc0 k2_fallback
k2_final:
    v_rcp_f32 v149, v149
    s_nop 0
    v_mul_f32 v20, v20, v149
    v_mul_f32 v21, v21, v149
    v_mul_f32 v22, v22, v149
    v_mul_f32 v23, v23, v149
    v_mul_f32 v24, v24, v149
    v_mul_f32 v25, v25, v149
    v_mul_f32 v26, v26, v149
    v_mul_f32 v27, v27, v149
    v_mul_f32 v28, v28, v149
    v_mul_f32 v29, v29, v149
    v_mul_f32 v30, v30, v149
    v_mul_f32 v31, v31, v149
    v_cvt_pk_bf16_f32 v68, v20, v21
    v_cvt_pk_bf16_f32 v69, v22, v23
    v_cvt_pk_bf16_f32 v70, v24, v25
    v_cvt_pk_bf16_f32 v71, v26, v27
    v_cvt_pk_bf16_f32 v72, v28, v29
    v_cvt_pk_bf16_f32 v73, v30, v31
    buffer_store_dwordx4 v[68:71], v140, s[16:19], s63 offen sc1
    s_mov_b32 exec_hi, 0
    buffer_store_dwordx2 v[72:73], v141, s[16:19], s60 offen offset:2048 sc1
    s_branch p3_tail
k2_end:
    s_endpgm
k2_wait1:
    s_barrier
    s_branch k2_go1
k2_wait3:
    s_setprio 0
k2_spin3:
    s_sleep 6
    ds_read_b32 v143, v145
    s_waitcnt lgkmcnt(0)
    v_readfirstlane_b32 s62, v143
    s_nop 0
    s_cmp_ge_u32 s62, s61
    s_cbranch_scc0 k2_spin3
    s_setprio 2
    s_branch k2_go3
k2_wait7:
    s_setprio 0
k2_spin7:
    s_sleep 6
    ds_read_b32 v143, v145
    s_waitcnt lgkmcnt(0)
    v_readfirstlane_b32 s62, v143
    s_nop 0
    s_cmp_ge_u32 s62, s61
    s_cbranch_scc0 k2_spin7
    s_setprio 2
    s_branch k2_go7
k2_fallback:
    s_mul_i32 s54, s36, 167936
    s_add_u32 s54, s54, 2621440
    v_lshlrev_b32 v152, 1, v141
    v_mov_b32 v151, 0xff800000
    s_mul_i32 s55, s41, 10496
    s_add_u32 s55, s55, 40960
    v_subrev_u32 v130, s55, v130
    v_min_u32 v130, 5120, v130
    v_subrev_u32 v131, s55, v131
    v_min_u32 v131, 5120, v131
    v_subrev_u32 v132, s55, v132
    v_min_u32 v132, 5120, v132
    v_subrev_u32 v133, s55, v133
    v_min_u32 v133, 5120, v133
    s_mov_b32 s55, 0
k2_fb0:
    s_lshr_b32 s56, s55, 1
    s_mul_i32 s56, s56, 5248
    s_add_u32 s56, s56, s54
    s_and_b32 s57, s55, 1
    s_lshl_b32 s58, s57, 10
    s_add_u32 s58, s58, s56
    buffer_load_dwordx4 v[96:99], v140, s[16:19], s58 offen
    s_lshl_b32 s58, s57, 3
    s_add_u32 s58, s58, s56
    buffer_load_dwordx2 v[104:105], v152, s[16:19], s58 offen offset:2048
    s_waitcnt vmcnt(0)
    v_mfma_f32_32x32x16_bf16 v[36:51], v[96:99], v[88:91], 0
    v_mfma_f32_32x32x8bf16_1k v[36:51], v[104:105], v[94:95], v[36:51]
    s_nop 11
    v_max3_f32 v151, v151, v36, v37
    v_max3_f32 v151, v151, v38, v39
    v_max3_f32 v151, v151, v40, v41
    v_max3_f32 v151, v151, v42, v43
    v_max3_f32 v151, v151, v44, v45
    v_max3_f32 v151, v151, v46, v47
    v_max3_f32 v151, v151, v48, v49
    v_max3_f32 v151, v151, v50, v51
    s_add_u32 s55, s55, 1
    s_cmp_lt_u32 s55, 64
    s_cbranch_scc1 k2_fb0
    v_mov_b32 v150, v151
    v_mov_b32 v20, 0
    v_mov_b32 v21, 0
    v_mov_b32 v22, 0
    v_mov_b32 v23, 0
    v_mov_b32 v24, 0
    v_mov_b32 v25, 0
    v_mov_b32 v26, 0
    v_mov_b32 v27, 0
    v_mov_b32 v28, 0
    v_mov_b32 v29, 0
    v_mov_b32 v30, 0
    v_mov_b32 v31, 0
    v_mov_b32 v32, 0
    v_mov_b32 v33, 0
    v_mov_b32 v34, 0
    v_mov_b32 v35, 0
    v_permlane32_swap_b32 v151, v150
    s_nop 0
    v_max_f32 v151, v151, v150
    s_mov_b32 s55, 0
k2_fb1:
    s_lshr_b32 s56, s55, 1
    s_mul_i32 s56, s56, 5248
    s_add_u32 s56, s56, s54
    s_and_b32 s57, s55, 1
    s_lshl_b32 s58, s57, 10
    s_add_u32 s58, s58, s56
    buffer_load_dwordx4 v[96:99], v140, s[16:19], s58 offen
    s_lshl_b32 s58, s57, 3
    s_add_u32 s58, s58, s56
    buffer_load_dwordx2 v[104:105], v152, s[16:19], s58 offen offset:2048
    s_cmp_eq_u32 s57, 0
    s_cselect_b64 vcc, -1, 0
    v_cndmask_b32 v136, v132, v130, vcc
    v_cndmask_b32 v137, v133, v131, vcc
    buffer_load_dwordx4 v[112:115], v136, s[16:19], s56 offen
    buffer_load_dwordx4 v[116:119], v137, s[16:19], s56 offen
    s_waitcnt vmcnt(0)
    v_mfma_f32_32x32x16_bf16 v[36:51], v[96:99], v[88:91], 0
    v_mfma_f32_32x32x8bf16_1k v[36:51], v[104:105], v[94:95], v[36:51]
    s_nop 11
    v_sub_f32 v36, v36, v151
    v_sub_f32 v37, v37, v151
    v_sub_f32 v38, v38, v151
    v_sub_f32 v39, v39, v151
    v_sub_f32 v40, v40, v151
    v_sub_f32 v41, v41, v151
    v_sub_f32 v42, v42, v151
    v_sub_f32 v43, v43, v151
    v_sub_f32 v44, v44, v151
    v_sub_f32 v45, v45, v151
    v_sub_f32 v46, v46, v151
    v_sub_f32 v47, v47, v151
    v_sub_f32 v48, v48, v151
    v_sub_f32 v49, v49, v151
    v_sub_f32 v50, v50, v151
    v_sub_f32 v51, v51, v151
    v_exp_f32 v36, v36
    v_exp_f32 v37, v37
    v_exp_f32 v38, v38
    v_exp_f32 v39, v39
    v_exp_f32 v40, v40
    v_exp_f32 v41, v41
    v_exp_f32 v42, v42
    v_exp_f32 v43, v43
    v_exp_f32 v44, v44
    v_exp_f32 v45, v45
    v_exp_f32 v46, v46
    v_exp_f32 v47, v47
    v_exp_f32 v48, v48
    v_exp_f32 v49, v49
    v_exp_f32 v50, v50
    v_exp_f32 v51, v51
    s_nop 0
    v_cvt_pk_bf16_f32 v68, v36, v37
    v_cvt_pk_bf16_f32 v69, v38, v39
    v_cvt_pk_bf16_f32 v70, v40, v41
    v_cvt_pk_bf16_f32 v71, v42, v43
    v_cvt_pk_bf16_f32 v72, v44, v45
    v_cvt_pk_bf16_f32 v73, v46, v47
    v_cvt_pk_bf16_f32 v74, v48, v49
    v_cvt_pk_bf16_f32 v75, v50, v51
    s_nop 1
    v_mfma_f32_32x32x16_bf16 v[20:35], v[112:115], v[68:71], v[20:35]
    v_mfma_f32_32x32x16_bf16 v[20:35], v[116:119], v[72:75], v[20:35]
    s_add_u32 s55, s55, 1
    s_cmp_lt_u32 s55, 64
    s_cbranch_scc1 k2_fb1
    v_cmp_gt_u32 vcc, 32, v0
    s_nop 11
    v_cndmask_b32 v149, v28, v32, vcc
    s_branch k2_final
k2_helpers:
    s_waitcnt lgkmcnt(0)
    s_mov_b32 s16, s4
    s_and_b32 s17, s5, 0xffff
    s_mov_b32 s18, 16777216
    s_mov_b32 s19, 0x00020000
    s_cmp_eq_u32 s38, 8
    s_cbranch_scc1 k2_loader
    s_sub_u32 s40, s38, 9
    s_lshr_b32 s44, s2, 3
    s_cmp_ge_u32 s44, 7
    s_cbranch_scc1 k2_woarr
    s_and_b32 s45, s2, 7
    s_mul_i32 s45, s45, 7
    s_add_u32 s41, s45, s44
    s_cmp_ge_u32 s41, 54
    s_cbranch_scc1 k2_end
    s_cmp_eq_u32 s40, 2
    s_cbranch_scc1 k2_feed
    s_load_dwordx2 s[4:5], s[0:1], 0
    s_load_dwordx2 s[10:11], s[0:1], 72
    v_and_b32 v124, 7, v0
    v_lshlrev_b32 v124, 2, v124
    v_mov_b32 v113, v124
    v_and_b32 v127, 15, v0
    v_lshrrev_b32 v128, 4, v0
    v_cmp_eq_u32 vcc, 8, v127
    v_mov_b32 v129, 0x3f803f80
    v_mov_b32 v116, 0
    v_cndmask_b32 v129, 0, v129, vcc
    v_mov_b32 v4, v129
    v_mov_b32 v5, v129
    v_mov_b64 v[6:7], v[4:5]
    v_mov_b64 v[8:9], v[4:5]
    v_mov_b64 v[10:11], v[4:5]
    v_mov_b64 v[12:13], v[4:5]
    v_mov_b64 v[14:15], v[4:5]
    v_mov_b64 v[16:17], v[4:5]
    v_mov_b64 v[18:19], v[4:5]
    v_mov_b64 v[20:21], v[4:5]
    v_mov_b64 v[22:23], v[4:5]
    v_mov_b64 v[24:25], v[4:5]
    v_mov_b64 v[26:27], v[4:5]
    v_mov_b64 v[28:29], v[4:5]
    v_mov_b64 v[30:31], v[4:5]
    v_mov_b64 v[32:33], v[4:5]
    v_mov_b64 v[34:35], v[4:5]
    v_mov_b64 v[36:37], v[4:5]
    v_mov_b64 v[38:39], v[4:5]
    v_mov_b64 v[40:41], v[4:5]
    v_mov_b64 v[42:43], v[4:5]
    v_mov_b64 v[44:45], v[4:5]
    v_mov_b64 v[46:47], v[4:5]
    v_mov_b64 v[48:49], v[4:5]
    v_mov_b64 v[50:51], v[4:5]
    v_mov_b64 v[52:53], v[4:5]
    v_mov_b64 v[54:55], v[4:5]
    v_mov_b64 v[56:57], v[4:5]
    v_mov_b64 v[58:59], v[4:5]
    v_mov_b64 v[60:61], v[4:5]
    v_mov_b64 v[62:63], v[4:5]
    v_mov_b64 v[64:65], v[4:5]
    v_mov_b64 v[66:67], v[4:5]
    v_mov_b64 v[68:69], v[4:5]
    v_mov_b64 v[70:71], v[4:5]
    v_mov_b64 v[72:73], v[4:5]
    v_mov_b64 v[74:75], v[4:5]
    v_mov_b64 v[76:77], v[4:5]
    v_mov_b64 v[78:79], v[4:5]
    v_mov_b64 v[80:81], v[4:5]
    v_mov_b64 v[82:83], v[4:5]
    v_mov_b32 v114, 0
    v_mov_b32 v115, 0
    s_waitcnt lgkmcnt(0)
    s_mov_b32 s12, s4
    s_and_b32 s13, s5, 0xffff
    s_mov_b32 s14, 2621440
    s_mov_b32 s15, 0x00020000
    v_bfe_u32 v124, v0, 2, 2
    v_lshl_add_u32 v125, v128, 3, v124
    v_lshlrev_b32 v125, 6, v125
    v_and_b32 v126, 1, v128
    v_xor_b32 v126, s40, v126
    v_lshl_add_u32 v125, v126, 5, v125
    v_and_b32 v126, 3, v0
    v_lshl_add_u32 v117, v126, 3, v125
    v_mov_b32 v100, 0
    v_mov_b32 v104, 0
    v_mov_b32 v101, 0
    v_mov_b32 v105, 0
    v_mov_b32 v102, 0
    v_mov_b32 v106, 0
    v_mov_b32 v103, 0
    v_mov_b32 v107, 0
    s_lshl_b32 s44, s40, 2
    s_add_u32 s45, s44, 160772
    v_mov_b32 v122, s45
    s_sub_u32 s45, 160776, s44
    v_mov_b32 v123, s45
    v_mov_b32 v133, 160768
    v_lshlrev_b32 v119, 3, v0
    v_add_u32 v119, 159744, v119
    s_lshl_b32 s44, s40, 9
    v_add_u32 v120, s44, v119
    v_bfe_u32 v124, v0, 2, 2
    v_lshl_add_u32 v124, v128, 2, v124
    v_mul_u32_u24 v124, 1280, v124
    v_and_b32 v125, 3, v0
    v_lshl_add_u32 v124, v125, 3, v124
    s_mul_i32 s44, s40, 640
    s_add_u32 s44, s44, 0
    v_add_u32 v118, s44, v124
    v_mul_u32_u24 v124, 138240, v127
    v_lshl_add_u32 v124, v128, 4, v124
    v_cmp_gt_u32 vcc, 8, v127
    v_mov_b32 v125, 0x40000000
    s_mul_i32 s44, s41, 320
    v_cndmask_b32 v121, v125, v124, vcc
    s_mul_i32 s45, s40, 69120
    s_add_u32 s44, s44, s45
    s_add_u32 s52, s44, 11440128
    s_add_u32 s53, s52, 17280
    s_add_u32 s54, s52, 34560
    s_add_u32 s55, s52, 51840
    s_barrier
    s_barrier
    s_barrier
    s_setprio 3
k2_w0:
    ds_read_b32 v132, v133 offset:0
    s_waitcnt lgkmcnt(0)
    v_cmp_gt_u32 vcc, 4, v132
    s_nop 4
    s_cbranch_vccz k2_w0_ok
    s_sleep 10
    s_branch k2_w0
k2_w0_ok:
    s_mov_b32 s20, s10
    s_and_b32 s21, s11, 0xffff
    s_mov_b32 s22, 256
    s_mov_b32 s23, 0x00020000
    v_mov_b32 v124, 0
    s_mov_b32 s45, 0
k2_selw:
    buffer_load_dword v125, v124, s[20:23], 0 offen offset:8 sc1
    s_add_u32 s45, s45, 1
    s_waitcnt vmcnt(0)
    v_readfirstlane_b32 s47, v125
    s_cmp_gt_u32 s45, 0x4000
    s_cbranch_scc1 k2_selok
    s_cmp_lg_u32 s47, 0
    s_cbranch_scc1 k2_selok
    s_sleep 16
    s_branch k2_selw
k2_selok:
    s_mov_b32 s46, 12562944
    buffer_load_dword v112, v113, s[16:19], s46 offen sc1
    s_waitcnt vmcnt(0)
    v_and_b32 v125, 0x7ff, v112
    v_sub_u32 v125, 2047, v125
    v_lshlrev_b32 v130, 3, v125
    v_mul_u32_u24 v125, 1280, v125
    v_lshl_add_u32 v131, v128, 4, v125
    s_mov_b32 s44, 12546048
    s_mov_b32 exec_lo, 0x00ff00ff
    s_mov_b32 exec_hi, 0x00ff00ff
    buffer_load_dwordx2 v[114:115], v130, s[16:19], s44 offen sc1
    buffer_load_dwordx4 v[4:7], v131, s[12:15], 0 offen offset:0
    buffer_load_dwordx4 v[8:11], v131, s[12:15], 0 offen offset:64
    buffer_load_dwordx4 v[12:15], v131, s[12:15], 0 offen offset:128
    buffer_load_dwordx4 v[16:19], v131, s[12:15], 0 offen offset:192
    buffer_load_dwordx4 v[20:23], v131, s[12:15], 0 offen offset:256
    buffer_load_dwordx4 v[24:27], v131, s[12:15], 0 offen offset:320
    buffer_load_dwordx4 v[28:31], v131, s[12:15], 0 offen offset:384
    buffer_load_dwordx4 v[32:35], v131, s[12:15], 0 offen offset:448
    buffer_load_dwordx4 v[36:39], v131, s[12:15], 0 offen offset:512
    buffer_load_dwordx4 v[40:43], v131, s[12:15], 0 offen offset:576
    buffer_load_dwordx4 v[44:47], v131, s[12:15], 0 offen offset:640
    buffer_load_dwordx4 v[48:51], v131, s[12:15], 0 offen offset:704
    buffer_load_dwordx4 v[52:55], v131, s[12:15], 0 offen offset:768
    buffer_load_dwordx4 v[56:59], v131, s[12:15], 0 offen offset:832
    buffer_load_dwordx4 v[60:63], v131, s[12:15], 0 offen offset:896
    buffer_load_dwordx4 v[64:67], v131, s[12:15], 0 offen offset:960
    buffer_load_dwordx4 v[68:71], v131, s[12:15], 0 offen offset:1024
    buffer_load_dwordx4 v[72:75], v131, s[12:15], 0 offen offset:1088
    buffer_load_dwordx4 v[76:79], v131, s[12:15], 0 offen offset:1152
    buffer_load_dwordx4 v[80:83], v131, s[12:15], 0 offen offset:1216
    s_mov_b64 exec, -1
    s_waitcnt vmcnt(0)
k2_w1:
    ds_read_b32 v132, v133 offset:12
    s_waitcnt lgkmcnt(0)
    v_cmp_gt_u32 vcc, 1, v132
    s_nop 4
    s_cbranch_vccz k2_w1_ok
    s_sleep 10
    s_branch k2_w1
k2_w1_ok:
    ds_read_b64_tr_b16 v[84:85], v117 offset:0
    ds_read_b64_tr_b16 v[86:87], v117 offset:256
    ds_read_b64_tr_b16 v[88:89], v117 offset:2048
    ds_read_b64_tr_b16 v[90:91], v117 offset:2304
    ds_read_b64_tr_b16 v[92:93], v117 offset:4096
    ds_read_b64_tr_b16 v[94:95], v117 offset:4352
    ds_read_b64_tr_b16 v[96:97], v117 offset:6144
    ds_read_b64_tr_b16 v[98:99], v117 offset:6400
    s_waitcnt lgkmcnt(4)
    v_mfma_f32_16x16x32_bf16 v[100:103], v[84:87], v[4:7], v[100:103]
    v_mfma_f32_16x16x32_bf16 v[100:103], v[88:91], v[8:11], v[100:103]
    ds_read_b64_tr_b16 v[84:85], v117 offset:8192
    ds_read_b64_tr_b16 v[86:87], v117 offset:8448
    ds_read_b64_tr_b16 v[88:89], v117 offset:10240
    ds_read_b64_tr_b16 v[90:91], v117 offset:10496
    s_waitcnt lgkmcnt(4)
    v_mfma_f32_16x16x32_bf16 v[100:103], v[92:95], v[12:15], v[100:103]
    v_mfma_f32_16x16x32_bf16 v[100:103], v[96:99], v[16:19], v[100:103]
    ds_read_b64_tr_b16 v[92:93], v117 offset:12288
    ds_read_b64_tr_b16 v[94:95], v117 offset:12544
    ds_read_b64_tr_b16 v[96:97], v117 offset:14336
    ds_read_b64_tr_b16 v[98:99], v117 offset:14592
    s_waitcnt lgkmcnt(4)
    v_mfma_f32_16x16x32_bf16 v[100:103], v[84:87], v[20:23], v[100:103]
    v_mfma_f32_16x16x32_bf16 v[100:103], v[88:91], v[24:27], v[100:103]
    ds_read_b64_tr_b16 v[84:85], v117 offset:16384
    ds_read_b64_tr_b16 v[86:87], v117 offset:16640
    ds_read_b64_tr_b16 v[88:89], v117 offset:18432
    ds_read_b64_tr_b16 v[90:91], v117 offset:18688
    s_waitcnt lgkmcnt(4)
    v_mfma_f32_16x16x32_bf16 v[100:103], v[92:95], v[28:31], v[100:103]
    v_mfma_f32_16x16x32_bf16 v[100:103], v[96:99], v[32:35], v[100:103]
    ds_read_b64_tr_b16 v[92:93], v117 offset:20480
    ds_read_b64_tr_b16 v[94:95], v117 offset:20736
    ds_read_b64_tr_b16 v[96:97], v117 offset:22528
    ds_read_b64_tr_b16 v[98:99], v117 offset:22784
    s_waitcnt lgkmcnt(4)
    v_mfma_f32_16x16x32_bf16 v[100:103], v[84:87], v[36:39], v[100:103]
    v_mfma_f32_16x16x32_bf16 v[100:103], v[88:91], v[40:43], v[100:103]
    ds_read_b64_tr_b16 v[84:85], v117 offset:24576
    ds_read_b64_tr_b16 v[86:87], v117 offset:24832
    ds_read_b64_tr_b16 v[88:89], v117 offset:26624
    ds_read_b64_tr_b16 v[90:91], v117 offset:26880
    s_waitcnt lgkmcnt(4)
    v_mfma_f32_16x16x32_bf16 v[100:103], v[92:95], v[44:47], v[100:103]
    v_mfma_f32_16x16x32_bf16 v[100:103], v[96:99], v[48:51], v[100:103]
    ds_read_b64_tr_b16 v[92:93], v117 offset:28672
    ds_read_b64_tr_b16 v[94:95], v117 offset:28928
    ds_read_b64_tr_b16 v[96:97], v117 offset:30720
    ds_read_b64_tr_b16 v[98:99], v117 offset:30976
    s_waitcnt lgkmcnt(4)
    v_mfma_f32_16x16x32_bf16 v[100:103], v[84:87], v[52:55], v[100:103]
    v_mfma_f32_16x16x32_bf16 v[100:103], v[88:91], v[56:59], v[100:103]
    ds_read_b64_tr_b16 v[84:85], v117 offset:32768
    ds_read_b64_tr_b16 v[86:87], v117 offset:33024
    ds_read_b64_tr_b16 v[88:89], v117 offset:34816
    ds_read_b64_tr_b16 v[90:91], v117 offset:35072
    s_waitcnt lgkmcnt(4)
    v_mfma_f32_16x16x32_bf16 v[100:103], v[92:95], v[60:63], v[100:103]
    v_mfma_f32_16x16x32_bf16 v[100:103], v[96:99], v[64:67], v[100:103]
    ds_read_b64_tr_b16 v[92:93], v117 offset:36864
    ds_read_b64_tr_b16 v[94:95], v117 offset:37120
    ds_read_b64_tr_b16 v[96:97], v117 offset:38912
    ds_read_b64_tr_b16 v[98:99], v117 offset:39168
    s_waitcnt lgkmcnt(4)
    v_mfma_f32_16x16x32_bf16 v[100:103], v[84:87], v[68:71], v[100:103]
    v_mfma_f32_16x16x32_bf16 v[100:103], v[88:91], v[72:75], v[100:103]
    s_waitcnt lgkmcnt(0)
    v_mfma_f32_16x16x32_bf16 v[100:103], v[92:95], v[76:79], v[100:103]
    v_mfma_f32_16x16x32_bf16 v[100:103], v[96:99], v[80:83], v[100:103]
    v_mov_b32 v132, 1
    ds_write_b32 v122, v132
k2_w2:
    ds_read_b32 v132, v133 offset:12
    s_waitcnt lgkmcnt(0)
    v_cmp_gt_u32 vcc, 2, v132
    s_nop 4
    s_cbranch_vccz k2_w2_ok
    s_sleep 10
    s_branch k2_w2
k2_w2_ok:
    ds_read_b64_tr_b16 v[84:85], v117 offset:0
    ds_read_b64_tr_b16 v[86:87], v117 offset:256
    ds_read_b64_tr_b16 v[88:89], v117 offset:2048
    ds_read_b64_tr_b16 v[90:91], v117 offset:2304
    ds_read_b64_tr_b16 v[92:93], v117 offset:4096
    ds_read_b64_tr_b16 v[94:95], v117 offset:4352
    ds_read_b64_tr_b16 v[96:97], v117 offset:6144
    ds_read_b64_tr_b16 v[98:99], v117 offset:6400
    s_waitcnt lgkmcnt(4)
    v_mfma_f32_16x16x32_bf16 v[104:107], v[84:87], v[4:7], v[104:107]
    v_mfma_f32_16x16x32_bf16 v[104:107], v[88:91], v[8:11], v[104:107]
    ds_read_b64_tr_b16 v[84:85], v117 offset:8192
    ds_read_b64_tr_b16 v[86:87], v117 offset:8448
    ds_read_b64_tr_b16 v[88:89], v117 offset:10240
    ds_read_b64_tr_b16 v[90:91], v117 offset:10496
    s_waitcnt lgkmcnt(4)
    v_mfma_f32_16x16x32_bf16 v[104:107], v[92:95], v[12:15], v[104:107]
    v_mfma_f32_16x16x32_bf16 v[104:107], v[96:99], v[16:19], v[104:107]
    ds_read_b64_tr_b16 v[92:93], v117 offset:12288
    ds_read_b64_tr_b16 v[94:95], v117 offset:12544
    ds_read_b64_tr_b16 v[96:97], v117 offset:14336
    ds_read_b64_tr_b16 v[98:99], v117 offset:14592
    s_waitcnt lgkmcnt(4)
    v_mfma_f32_16x16x32_bf16 v[104:107], v[84:87], v[20:23], v[104:107]
    v_mfma_f32_16x16x32_bf16 v[104:107], v[88:91], v[24:27], v[104:107]
    ds_read_b64_tr_b16 v[84:85], v117 offset:16384
    ds_read_b64_tr_b16 v[86:87], v117 offset:16640
    ds_read_b64_tr_b16 v[88:89], v117 offset:18432
    ds_read_b64_tr_b16 v[90:91], v117 offset:18688
    s_waitcnt lgkmcnt(4)
    v_mfma_f32_16x16x32_bf16 v[104:107], v[92:95], v[28:31], v[104:107]
    v_mfma_f32_16x16x32_bf16 v[104:107], v[96:99], v[32:35], v[104:107]
    ds_read_b64_tr_b16 v[92:93], v117 offset:20480
    ds_read_b64_tr_b16 v[94:95], v117 offset:20736
    ds_read_b64_tr_b16 v[96:97], v117 offset:22528
    ds_read_b64_tr_b16 v[98:99], v117 offset:22784
    s_waitcnt lgkmcnt(4)
    v_mfma_f32_16x16x32_bf16 v[104:107], v[84:87], v[36:39], v[104:107]
    v_mfma_f32_16x16x32_bf16 v[104:107], v[88:91], v[40:43], v[104:107]
    ds_read_b64_tr_b16 v[84:85], v117 offset:24576
    ds_read_b64_tr_b16 v[86:87], v117 offset:24832
    ds_read_b64_tr_b16 v[88:89], v117 offset:26624
    ds_read_b64_tr_b16 v[90:91], v117 offset:26880
    s_waitcnt lgkmcnt(4)
    v_mfma_f32_16x16x32_bf16 v[104:107], v[92:95], v[44:47], v[104:107]
    v_mfma_f32_16x16x32_bf16 v[104:107], v[96:99], v[48:51], v[104:107]
    ds_read_b64_tr_b16 v[92:93], v117 offset:28672
    ds_read_b64_tr_b16 v[94:95], v117 offset:28928
    ds_read_b64_tr_b16 v[96:97], v117 offset:30720
    ds_read_b64_tr_b16 v[98:99], v117 offset:30976
    s_waitcnt lgkmcnt(4)
    v_mfma_f32_16x16x32_bf16 v[104:107], v[84:87], v[52:55], v[104:107]
    v_mfma_f32_16x16x32_bf16 v[104:107], v[88:91], v[56:59], v[104:107]
    ds_read_b64_tr_b16 v[84:85], v117 offset:32768
    ds_read_b64_tr_b16 v[86:87], v117 offset:33024
    ds_read_b64_tr_b16 v[88:89], v117 offset:34816
    ds_read_b64_tr_b16 v[90:91], v117 offset:35072
    s_waitcnt lgkmcnt(4)
    v_mfma_f32_16x16x32_bf16 v[104:107], v[92:95], v[60:63], v[104:107]
    v_mfma_f32_16x16x32_bf16 v[104:107], v[96:99], v[64:67], v[104:107]
    ds_read_b64_tr_b16 v[92:93], v117 offset:36864
    ds_read_b64_tr_b16 v[94:95], v117 offset:37120
    ds_read_b64_tr_b16 v[96:97], v117 offset:38912
    ds_read_b64_tr_b16 v[98:99], v117 offset:39168
    s_waitcnt lgkmcnt(4)
    v_mfma_f32_16x16x32_bf16 v[104:107], v[84:87], v[68:71], v[104:107]
    v_mfma_f32_16x16x32_bf16 v[104:107], v[88:91], v[72:75], v[104:107]
    s_waitcnt lgkmcnt(0)
    v_mfma_f32_16x16x32_bf16 v[104:107], v[92:95], v[76:79], v[104:107]
    v_mfma_f32_16x16x32_bf16 v[104:107], v[96:99], v[80:83], v[104:107]
    v_mov_b32 v132, 2
    ds_write_b32 v122, v132
    s_nop 5
    v_mov_b32_dpp v84, v100 row_newbcast:8 row_mask:0xf bank_mask:0xf
    v_mov_b32_dpp v88, v104 row_newbcast:8 row_mask:0xf bank_mask:0xf
    v_mov_b32_dpp v85, v101 row_newbcast:8 row_mask:0xf bank_mask:0xf
    v_mov_b32_dpp v89, v105 row_newbcast:8 row_mask:0xf bank_mask:0xf
    v_mov_b32_dpp v86, v102 row_newbcast:8 row_mask:0xf bank_mask:0xf
    v_mov_b32_dpp v90, v106 row_newbcast:8 row_mask:0xf bank_mask:0xf
    v_mov_b32_dpp v87, v103 row_newbcast:8 row_mask:0xf bank_mask:0xf
    v_mov_b32_dpp v91, v107 row_newbcast:8 row_mask:0xf bank_mask:0xf
    v_fmac_f32 v100, v114, v84
    v_fmac_f32 v104, v114, v88
    v_fmac_f32 v101, v114, v85
    v_fmac_f32 v105, v114, v89
    v_fmac_f32 v102, v114, v86
    v_fmac_f32 v106, v114, v90
    v_fmac_f32 v103, v114, v87
    v_fmac_f32 v107, v114, v91
    v_mul_f32 v100, v100, v115
    v_mul_f32 v104, v104, v115
    v_mul_f32 v101, v101, v115
    v_mul_f32 v105, v105, v115
    v_mul_f32 v102, v102, v115
    v_mul_f32 v106, v106, v115
    v_mul_f32 v103, v103, v115
    v_mul_f32 v107, v107, v115
    v_mul_f32 v84, 0xbfb8aa3b, v100
    v_mul_f32 v85, 0xbfb8aa3b, v101
    v_mul_f32 v86, 0xbfb8aa3b, v102
    v_mul_f32 v87, 0xbfb8aa3b, v103
    v_exp_f32 v84, v84
    v_exp_f32 v85, v85
    v_exp_f32 v86, v86
    v_exp_f32 v87, v87
    v_mul_f32 v104, v104, v100
    v_mul_f32 v105, v105, v101
    v_mul_f32 v106, v106, v102
    v_mul_f32 v107, v107, v103
    v_add_f32 v84, 1.0, v84
    v_add_f32 v85, 1.0, v85
    v_add_f32 v86, 1.0, v86
    v_add_f32 v87, 1.0, v87
    v_rcp_f32 v84, v84
    v_rcp_f32 v85, v85
    v_rcp_f32 v86, v86
    v_rcp_f32 v87, v87
    v_mul_f32 v104, v104, v84
    v_mul_f32 v105, v105, v85
    v_mul_f32 v106, v106, v86
    v_mul_f32 v107, v107, v87
    v_cvt_pk_bf16_f32 v108, v104, v105
    v_cvt_pk_bf16_f32 v109, v106, v107
    ds_write_b64 v120, v[108:109]
    v_mov_b32 v132, 3
    ds_write_b32 v122, v132
k2_w3:
    ds_read_b32 v132, v133 offset:12
    s_waitcnt lgkmcnt(0)
    v_cmp_gt_u32 vcc, 3, v132
    s_nop 4
    s_cbranch_vccz k2_w3_ok
    s_sleep 10
    s_branch k2_w3
k2_w3_ok:
k2_w4:
    ds_read_b32 v132, v123 offset:0
    s_waitcnt lgkmcnt(0)
    v_cmp_gt_u32 vcc, 3, v132
    s_nop 4
    s_cbranch_vccz k2_w4_ok
    s_sleep 4
    s_branch k2_w4
k2_w4_ok:
    ds_read_b64 v[108:109], v119
    ds_read_b64 v[110:111], v119 offset:512
    ds_read_b64_tr_b16 v[84:85], v118 offset:0
    ds_read_b64_tr_b16 v[86:87], v118 offset:20480
    ds_read_b64_tr_b16 v[88:89], v118 offset:32
    ds_read_b64_tr_b16 v[90:91], v118 offset:20512
    ds_read_b64_tr_b16 v[92:93], v118 offset:64
    ds_read_b64_tr_b16 v[94:95], v118 offset:20544
    ds_read_b64_tr_b16 v[96:97], v118 offset:96
    ds_read_b64_tr_b16 v[98:99], v118 offset:20576
    s_waitcnt lgkmcnt(4)
    v_mfma_f32_16x16x32_bf16 v[4:7], v[84:87], v[108:111], 0
    v_mfma_f32_16x16x32_bf16 v[8:11], v[88:91], v[108:111], 0
    ds_read_b64_tr_b16 v[84:85], v118 offset:128
    ds_read_b64_tr_b16 v[86:87], v118 offset:20608
    ds_read_b64_tr_b16 v[88:89], v118 offset:160
    ds_read_b64_tr_b16 v[90:91], v118 offset:20640
    s_waitcnt lgkmcnt(4)
    v_mfma_f32_16x16x32_bf16 v[12:15], v[92:95], v[108:111], 0
    v_mfma_f32_16x16x32_bf16 v[16:19], v[96:99], v[108:111], 0
    ds_read_b64_tr_b16 v[92:93], v118 offset:192
    ds_read_b64_tr_b16 v[94:95], v118 offset:20672
    ds_read_b64_tr_b16 v[96:97], v118 offset:224
    ds_read_b64_tr_b16 v[98:99], v118 offset:20704
    s_waitcnt lgkmcnt(4)
    v_mfma_f32_16x16x32_bf16 v[20:23], v[84:87], v[108:111], 0
    v_mfma_f32_16x16x32_bf16 v[24:27], v[88:91], v[108:111], 0
    buffer_store_dwordx4 v[4:7], v121, s[16:19], s52 offen offset:0 sc1
    buffer_store_dwordx4 v[8:11], v121, s[16:19], s52 offen offset:64 sc1
    ds_read_b64_tr_b16 v[84:85], v118 offset:256
    ds_read_b64_tr_b16 v[86:87], v118 offset:20736
    ds_read_b64_tr_b16 v[88:89], v118 offset:288
    ds_read_b64_tr_b16 v[90:91], v118 offset:20768
    s_waitcnt lgkmcnt(4)
    v_mfma_f32_16x16x32_bf16 v[28:31], v[92:95], v[108:111], 0
    v_mfma_f32_16x16x32_bf16 v[32:35], v[96:99], v[108:111], 0
    buffer_store_dwordx4 v[12:15], v121, s[16:19], s52 offen offset:128 sc1
    buffer_store_dwordx4 v[16:19], v121, s[16:19], s52 offen offset:192 sc1
    ds_read_b64_tr_b16 v[92:93], v118 offset:320
    ds_read_b64_tr_b16 v[94:95], v118 offset:20800
    ds_read_b64_tr_b16 v[96:97], v118 offset:352
    ds_read_b64_tr_b16 v[98:99], v118 offset:20832
    s_waitcnt lgkmcnt(4)
    v_mfma_f32_16x16x32_bf16 v[36:39], v[84:87], v[108:111], 0
    v_mfma_f32_16x16x32_bf16 v[40:43], v[88:91], v[108:111], 0
    buffer_store_dwordx4 v[20:23], v121, s[16:19], s52 offen offset:256 sc1
    buffer_store_dwordx4 v[24:27], v121, s[16:19], s53 offen offset:0 sc1
    ds_read_b64_tr_b16 v[84:85], v118 offset:384
    ds_read_b64_tr_b16 v[86:87], v118 offset:20864
    ds_read_b64_tr_b16 v[88:89], v118 offset:416
    ds_read_b64_tr_b16 v[90:91], v118 offset:20896
    s_waitcnt lgkmcnt(4)
    v_mfma_f32_16x16x32_bf16 v[44:47], v[92:95], v[108:111], 0
    v_mfma_f32_16x16x32_bf16 v[48:51], v[96:99], v[108:111], 0
    buffer_store_dwordx4 v[28:31], v121, s[16:19], s53 offen offset:64 sc1
    buffer_store_dwordx4 v[32:35], v121, s[16:19], s53 offen offset:128 sc1
    ds_read_b64_tr_b16 v[92:93], v118 offset:448
    ds_read_b64_tr_b16 v[94:95], v118 offset:20928
    ds_read_b64_tr_b16 v[96:97], v118 offset:480
    ds_read_b64_tr_b16 v[98:99], v118 offset:20960
    s_waitcnt lgkmcnt(4)
    v_mfma_f32_16x16x32_bf16 v[52:55], v[84:87], v[108:111], 0
    v_mfma_f32_16x16x32_bf16 v[56:59], v[88:91], v[108:111], 0
    buffer_store_dwordx4 v[36:39], v121, s[16:19], s53 offen offset:192 sc1
    buffer_store_dwordx4 v[40:43], v121, s[16:19], s53 offen offset:256 sc1
    ds_read_b64_tr_b16 v[84:85], v118 offset:512
    ds_read_b64_tr_b16 v[86:87], v118 offset:20992
    ds_read_b64_tr_b16 v[88:89], v118 offset:544
    ds_read_b64_tr_b16 v[90:91], v118 offset:21024
    s_waitcnt lgkmcnt(4)
    v_mfma_f32_16x16x32_bf16 v[60:63], v[92:95], v[108:111], 0
    v_mfma_f32_16x16x32_bf16 v[64:67], v[96:99], v[108:111], 0
    buffer_store_dwordx4 v[44:47], v121, s[16:19], s54 offen offset:0 sc1
    buffer_store_dwordx4 v[48:51], v121, s[16:19], s54 offen offset:64 sc1
    ds_read_b64_tr_b16 v[92:93], v118 offset:576
    ds_read_b64_tr_b16 v[94:95], v118 offset:21056
    ds_read_b64_tr_b16 v[96:97], v118 offset:608
    ds_read_b64_tr_b16 v[98:99], v118 offset:21088
    s_waitcnt lgkmcnt(4)
    v_mfma_f32_16x16x32_bf16 v[68:71], v[84:87], v[108:111], 0
    v_mfma_f32_16x16x32_bf16 v[72:75], v[88:91], v[108:111], 0
    buffer_store_dwordx4 v[52:55], v121, s[16:19], s54 offen offset:128 sc1
    buffer_store_dwordx4 v[56:59], v121, s[16:19], s54 offen offset:192 sc1
    s_waitcnt lgkmcnt(0)
    v_mfma_f32_16x16x32_bf16 v[76:79], v[92:95], v[108:111], 0
    v_mfma_f32_16x16x32_bf16 v[80:83], v[96:99], v[108:111], 0
    buffer_store_dwordx4 v[60:63], v121, s[16:19], s54 offen offset:256 sc1
    buffer_store_dwordx4 v[64:67], v121, s[16:19], s55 offen offset:0 sc1
    s_nop 3
    buffer_store_dwordx4 v[68:71], v121, s[16:19], s55 offen offset:64 sc1
    buffer_store_dwordx4 v[72:75], v121, s[16:19], s55 offen offset:128 sc1
    buffer_store_dwordx4 v[76:79], v121, s[16:19], s55 offen offset:192 sc1
    buffer_store_dwordx4 v[80:83], v121, s[16:19], s55 offen offset:256 sc1
    s_mov_b64 exec, 1
    s_mov_b32 s44, 12588032
    v_mov_b32 v1, 0
    v_mov_b32 v2, 1
    s_waitcnt vmcnt(0)
    buffer_atomic_add v2, v1, s[16:19], s44 offen sc1
    s_endpgm
k2_feed:
    s_load_dwordx4 s[8:11], s[0:1], 40
    s_load_dwordx2 s[6:7], s[0:1], 56
    v_lshrrev_b32 v1, 2, v0
    v_mul_u32_u24 v1, 3456, v1
    v_lshrrev_b32 v2, 5, v0
    v_lshlrev_b32 v2, 1, v2
    v_and_b32 v3, 3, v0
    v_xor_b32 v2, v2, v3
    v_lshl_add_u32 v1, v2, 4, v1
    s_lshl_b32 s44, s41, 6
    v_add_u32 v4, s44, v1
    v_add_u32 v5, 54272, v4
    v_add_u32 v6, 108544, v4
    v_add_u32 v7, 162816, v4
    v_lshlrev_b32 v8, 4, v0
    v_mov_b32 v9, 160768
    v_and_b32 v10, 1, v0
    v_lshl_add_u32 v10, v10, 2, v9
    s_waitcnt lgkmcnt(0)
    s_mov_b32 s20, s8
    s_and_b32 s21, s9, 0xffff
    s_mov_b32 s22, 2211840
    s_mov_b32 s23, 0x00020000
    s_mov_b32 s24, s10
    s_and_b32 s25, s11, 0xffff
    s_mov_b32 s26, 2211840
    s_mov_b32 s27, 0x00020000
    s_mov_b32 s28, s6
    s_and_b32 s29, s7, 0xffff
    s_mov_b32 s30, 2211840
    s_mov_b32 s31, 0x00020000
    s_barrier
    s_barrier
    s_barrier
    s_setprio 3
k2_f0:
    ds_read_b32 v11, v9 offset:0
    s_waitcnt lgkmcnt(0)
    v_cmp_gt_u32 vcc, 4, v11
    s_nop 4
    s_cbranch_vccz k2_f0_ok
    s_sleep 10
    s_branch k2_f0
k2_f0_ok:
    s_mov_b32 s42, 0
    s_mov_b32 s44, 0
k2_fd0:
    s_mov_b32 m0, s44
    s_add_u32 s44, s44, 4096
    buffer_load_dwordx4 v4, s[20:23], s42 offen offset:0 nt lds
    buffer_load_dwordx4 v5, s[20:23], s42 offen offset:1024 nt lds
    buffer_load_dwordx4 v6, s[20:23], s42 offen offset:2048 nt lds
    buffer_load_dwordx4 v7, s[20:23], s42 offen offset:3072 nt lds
    s_add_u32 s42, s42, 221184
    s_mov_b32 m0, s44
    s_add_u32 s44, s44, 4096
    buffer_load_dwordx4 v4, s[20:23], s42 offen offset:0 nt lds
    buffer_load_dwordx4 v5, s[20:23], s42 offen offset:1024 nt lds
    buffer_load_dwordx4 v6, s[20:23], s42 offen offset:2048 nt lds
    buffer_load_dwordx4 v7, s[20:23], s42 offen offset:3072 nt lds
    s_add_u32 s42, s42, 221184
    s_waitcnt vmcnt(8)
    s_cmp_lt_u32 s44, 40960
    s_cbranch_scc1 k2_fd0
    v_mov_b32 v11, 1
    s_waitcnt vmcnt(0)
    ds_write_b32 v9, v11 offset:12
k2_f1:
    ds_read_b32 v11, v10 offset:4
    s_waitcnt lgkmcnt(0)
    v_cmp_gt_u32 vcc, 1, v11
    s_nop 4
    s_cbranch_vccz k2_f1_ok
    s_sleep 6
    s_branch k2_f1
k2_f1_ok:
    s_mov_b32 s42, 0
    s_mov_b32 s44, 0
k2_fd1:
    s_mov_b32 m0, s44
    s_add_u32 s44, s44, 4096
    buffer_load_dwordx4 v4, s[24:27], s42 offen offset:0 nt lds
    buffer_load_dwordx4 v5, s[24:27], s42 offen offset:1024 nt lds
    buffer_load_dwordx4 v6, s[24:27], s42 offen offset:2048 nt lds
    buffer_load_dwordx4 v7, s[24:27], s42 offen offset:3072 nt lds
    s_add_u32 s42, s42, 221184
    s_mov_b32 m0, s44
    s_add_u32 s44, s44, 4096
    buffer_load_dwordx4 v4, s[24:27], s42 offen offset:0 nt lds
    buffer_load_dwordx4 v5, s[24:27], s42 offen offset:1024 nt lds
    buffer_load_dwordx4 v6, s[24:27], s42 offen offset:2048 nt lds
    buffer_load_dwordx4 v7, s[24:27], s42 offen offset:3072 nt lds
    s_add_u32 s42, s42, 221184
    s_waitcnt vmcnt(8)
    s_cmp_lt_u32 s44, 40960
    s_cbranch_scc1 k2_fd1
    v_mov_b32 v11, 2
    s_waitcnt vmcnt(0)
    ds_write_b32 v9, v11 offset:12
k2_f2:
    ds_read_b32 v11, v10 offset:4
    s_waitcnt lgkmcnt(0)
    v_cmp_gt_u32 vcc, 2, v11
    s_nop 4
    s_cbranch_vccz k2_f2_ok
    s_sleep 6
    s_branch k2_f2
k2_f2_ok:
    s_mul_i32 s42, s41, 40960
    s_mov_b32 s44, 0
k2_fd2:
    s_mov_b32 m0, s44
    s_add_u32 s44, s44, 4096
    buffer_load_dwordx4 v8, s[28:31], s42 offen offset:0 nt lds
    buffer_load_dwordx4 v8, s[28:31], s42 offen offset:1024 nt lds
    buffer_load_dwordx4 v8, s[28:31], s42 offen offset:2048 nt lds
    buffer_load_dwordx4 v8, s[28:31], s42 offen offset:3072 nt lds
    s_add_u32 s42, s42, 4096
    s_mov_b32 m0, s44
    s_add_u32 s44, s44, 4096
    buffer_load_dwordx4 v8, s[28:31], s42 offen offset:0 nt lds
    buffer_load_dwordx4 v8, s[28:31], s42 offen offset:1024 nt lds
    buffer_load_dwordx4 v8, s[28:31], s42 offen offset:2048 nt lds
    buffer_load_dwordx4 v8, s[28:31], s42 offen offset:3072 nt lds
    s_add_u32 s42, s42, 4096
    s_waitcnt vmcnt(8)
    s_cmp_lt_u32 s44, 40960
    s_cbranch_scc1 k2_fd2
    v_mov_b32 v11, 3
    s_waitcnt vmcnt(0)
    ds_write_b32 v9, v11 offset:12
    s_endpgm
k2_ahead:
    s_load_dwordx4 s[8:11], s[0:1], 40
    s_load_dwordx2 s[6:7], s[0:1], 56
    s_and_b32 s47, s2, 7
    s_lshr_b32 s48, s2, 3
    s_sub_u32 s48, s48, 7
    s_mul_i32 s44, s47, 448
    s_and_b32 s44, s44, 0xffffff80
    s_mul_i32 s45, s48, 89856
    s_add_u32 s44, s44, s45
    s_mul_i32 s46, s47, 286720
    s_mul_i32 s45, s48, 12288
    s_add_u32 s46, s46, s45
    v_lshlrev_b32 v8, 4, v0
    v_lshrrev_b32 v9, 5, v0
    v_mul_u32_u24 v9, 2944, v9
    v_add_u32 v9, v9, v8
    s_waitcnt lgkmcnt(0)
    s_mov_b32 s20, s8
    s_and_b32 s21, s9, 0xffff
    s_mov_b32 s22, 2211840
    s_mov_b32 s23, 0x00020000
    s_mov_b32 s24, s10
    s_and_b32 s25, s11, 0xffff
    s_mov_b32 s26, 2211840
    s_mov_b32 s27, 0x00020000
    s_mov_b32 s28, s6
    s_and_b32 s29, s7, 0xffff
    s_mov_b32 s30, 2211840
    s_mov_b32 s31, 0x00020000
    s_barrier
    s_barrier
    s_barrier
    s_mov_b32 s45, s44
    buffer_load_dwordx4 v[4:7], v9, s[20:23], s45 offen
    s_add_u32 s45, s45, 6912
    buffer_load_dwordx4 v[4:7], v9, s[20:23], s45 offen
    s_add_u32 s45, s45, 6912
    buffer_load_dwordx4 v[4:7], v9, s[20:23], s45 offen
    s_add_u32 s45, s45, 6912
    buffer_load_dwordx4 v[4:7], v9, s[20:23], s45 offen
    s_add_u32 s45, s45, 6912
    buffer_load_dwordx4 v[4:7], v9, s[20:23], s45 offen
    s_add_u32 s45, s45, 6912
    buffer_load_dwordx4 v[4:7], v9, s[20:23], s45 offen
    s_add_u32 s45, s45, 6912
    buffer_load_dwordx4 v[4:7], v9, s[20:23], s45 offen
    s_add_u32 s45, s45, 6912
    buffer_load_dwordx4 v[4:7], v9, s[20:23], s45 offen
    s_add_u32 s45, s45, 6912
    buffer_load_dwordx4 v[4:7], v9, s[20:23], s45 offen
    s_add_u32 s45, s45, 6912
    buffer_load_dwordx4 v[4:7], v9, s[20:23], s45 offen
    s_add_u32 s45, s45, 6912
    buffer_load_dwordx4 v[4:7], v9, s[20:23], s45 offen
    s_add_u32 s45, s45, 6912
    buffer_load_dwordx4 v[4:7], v9, s[20:23], s45 offen
    s_add_u32 s45, s45, 6912
    buffer_load_dwordx4 v[4:7], v9, s[20:23], s45 offen
    s_add_u32 s45, s45, 6912
    s_waitcnt vmcnt(0)
    s_mov_b32 s45, s44
    buffer_load_dwordx4 v[4:7], v9, s[24:27], s45 offen
    s_add_u32 s45, s45, 6912
    buffer_load_dwordx4 v[4:7], v9, s[24:27], s45 offen
    s_add_u32 s45, s45, 6912
    buffer_load_dwordx4 v[4:7], v9, s[24:27], s45 offen
    s_add_u32 s45, s45, 6912
    buffer_load_dwordx4 v[4:7], v9, s[24:27], s45 offen
    s_add_u32 s45, s45, 6912
    buffer_load_dwordx4 v[4:7], v9, s[24:27], s45 offen
    s_add_u32 s45, s45, 6912
    buffer_load_dwordx4 v[4:7], v9, s[24:27], s45 offen
    s_add_u32 s45, s45, 6912
    buffer_load_dwordx4 v[4:7], v9, s[24:27], s45 offen
    s_add_u32 s45, s45, 6912
    buffer_load_dwordx4 v[4:7], v9, s[24:27], s45 offen
    s_add_u32 s45, s45, 6912
    buffer_load_dwordx4 v[4:7], v9, s[24:27], s45 offen
    s_add_u32 s45, s45, 6912
    buffer_load_dwordx4 v[4:7], v9, s[24:27], s45 offen
    s_add_u32 s45, s45, 6912
    buffer_load_dwordx4 v[4:7], v9, s[24:27], s45 offen
    s_add_u32 s45, s45, 6912
    buffer_load_dwordx4 v[4:7], v9, s[24:27], s45 offen
    s_add_u32 s45, s45, 6912
    buffer_load_dwordx4 v[4:7], v9, s[24:27], s45 offen
    s_add_u32 s45, s45, 6912
    s_waitcnt vmcnt(0)
    buffer_load_dwordx4 v[4:7], v8, s[28:31], s46 offen offset:0
    buffer_load_dwordx4 v[4:7], v8, s[28:31], s46 offen offset:1024
    buffer_load_dwordx4 v[4:7], v8, s[28:31], s46 offen offset:2048
    buffer_load_dwordx4 v[4:7], v8, s[28:31], s46 offen offset:3072
    s_add_u32 s46, s46, 4096
    buffer_load_dwordx4 v[4:7], v8, s[28:31], s46 offen offset:0
    buffer_load_dwordx4 v[4:7], v8, s[28:31], s46 offen offset:1024
    buffer_load_dwordx4 v[4:7], v8, s[28:31], s46 offen offset:2048
    buffer_load_dwordx4 v[4:7], v8, s[28:31], s46 offen offset:3072
    s_add_u32 s46, s46, 4096
    buffer_load_dwordx4 v[4:7], v8, s[28:31], s46 offen offset:0
    buffer_load_dwordx4 v[4:7], v8, s[28:31], s46 offen offset:1024
    buffer_load_dwordx4 v[4:7], v8, s[28:31], s46 offen offset:2048
    buffer_load_dwordx4 v[4:7], v8, s[28:31], s46 offen offset:3072
    s_add_u32 s46, s46, 4096
    s_waitcnt vmcnt(0)
    s_endpgm
k2_woarr:
    s_cmp_eq_u32 s40, 2
    s_cbranch_scc1 k2_ahead
    s_sub_u32 s53, s2, 56
    s_lshl_b32 s53, s53, 1
    s_add_u32 s53, s53, s40
    s_cmp_ge_u32 s53, 160
    s_cbranch_scc1 k2_end
    s_load_dwordx2 s[4:5], s[0:1], 16
    s_mul_i32 s54, s53, 3277
    s_lshr_b32 s54, s54, 16
    s_mul_i32 s41, s54, 20
    s_sub_u32 s41, s53, s41
    v_lshrrev_b32 v24, 4, v0
    v_and_b32 v25, 15, v0
    s_cmp_lt_u32 s41, 16
    s_cbranch_scc1 k2_wo_main
    v_mul_u32_u24 v26, 40, v24
    s_mul_i32 s42, s41, 160
    s_sub_u32 s42, s42, 2544
    s_mov_b32 s43, 25600
    s_branch k2_wo_go
k2_wo_main:
    v_lshrrev_b32 v26, 1, v24
    v_mul_u32_u24 v26, 20, v26
    v_and_b32 v27, 1, v24
    v_lshl_add_u32 v26, v27, 2, v26
    s_mul_i32 s42, s41, 40
    s_mov_b32 s43, 10240
k2_wo_go:
    v_add_u32 v26, s42, v26
    v_mul_u32_u24 v26, 1280, v26
    s_mul_i32 s44, s54, 160
    v_add_u32 v26, s44, v26
    v_lshl_add_u32 v27, v25, 3, v26
    v_lshl_add_u32 v28, v25, 1, v26
    s_mov_b32 s47, 0x05040100
    s_mov_b32 s48, 0x07060302
    s_mul_i32 s49, s53, 5120
    s_add_u32 s49, s49, 10620928
    s_add_u32 s46, s49, 4096
    v_lshlrev_b32 v26, 4, v0
    s_waitcnt lgkmcnt(0)
    s_mov_b32 s32, s4
    s_and_b32 s33, s5, 0xffff
    s_mov_b32 s34, 819200
    s_mov_b32 s35, 0x00020000
    s_barrier
    s_barrier
    s_barrier
    s_setprio 3
    s_mov_b32 s45, 0
    buffer_load_dwordx2 v[32:33], v27, s[32:35], s45 offen
    buffer_load_ushort v48, v28, s[32:35], s45 offen offset:128
    s_add_u32 s45, s45, 1280
    buffer_load_dwordx2 v[34:35], v27, s[32:35], s45 offen
    buffer_load_ushort v49, v28, s[32:35], s45 offen offset:128
    s_add_u32 s45, s45, 1280
    buffer_load_dwordx2 v[36:37], v27, s[32:35], s45 offen
    buffer_load_ushort v50, v28, s[32:35], s45 offen offset:128
    s_add_u32 s45, s45, 1280
    buffer_load_dwordx2 v[38:39], v27, s[32:35], s45 offen
    buffer_load_ushort v51, v28, s[32:35], s45 offen offset:128
    s_mov_b32 s45, s43
    buffer_load_dwordx2 v[40:41], v27, s[32:35], s45 offen
    buffer_load_ushort v52, v28, s[32:35], s45 offen offset:128
    s_add_u32 s45, s45, 1280
    buffer_load_dwordx2 v[42:43], v27, s[32:35], s45 offen
    buffer_load_ushort v53, v28, s[32:35], s45 offen offset:128
    s_add_u32 s45, s45, 1280
    buffer_load_dwordx2 v[44:45], v27, s[32:35], s45 offen
    buffer_load_ushort v54, v28, s[32:35], s45 offen offset:128
    s_add_u32 s45, s45, 1280
    buffer_load_dwordx2 v[46:47], v27, s[32:35], s45 offen
    buffer_load_ushort v55, v28, s[32:35], s45 offen offset:128
    s_waitcnt vmcnt(0)
    v_perm_b32 v4, v34, v32, s47
    v_perm_b32 v8, v34, v32, s48
    v_perm_b32 v12, v35, v33, s47
    v_perm_b32 v16, v35, v33, s48
    v_lshl_or_b32 v20, v49, 16, v48
    v_perm_b32 v5, v38, v36, s47
    v_perm_b32 v9, v38, v36, s48
    v_perm_b32 v13, v39, v37, s47
    v_perm_b32 v17, v39, v37, s48
    v_lshl_or_b32 v21, v51, 16, v50
    v_perm_b32 v6, v42, v40, s47
    v_perm_b32 v10, v42, v40, s48
    v_perm_b32 v14, v43, v41, s47
    v_perm_b32 v18, v43, v41, s48
    v_lshl_or_b32 v22, v53, 16, v52
    v_perm_b32 v7, v46, v44, s47
    v_perm_b32 v11, v46, v44, s48
    v_perm_b32 v15, v47, v45, s47
    v_perm_b32 v19, v47, v45, s48
    v_lshl_or_b32 v23, v55, 16, v54
    buffer_store_dwordx4 v[4:7], v26, s[16:19], s49 offen offset:0 sc1
    buffer_store_dwordx4 v[8:11], v26, s[16:19], s49 offen offset:1024 sc1
    buffer_store_dwordx4 v[12:15], v26, s[16:19], s49 offen offset:2048 sc1
    buffer_store_dwordx4 v[16:19], v26, s[16:19], s49 offen offset:3072 sc1
    buffer_store_dwordx4 v[20:23], v26, s[16:19], s46 offen sc1
    s_mov_b64 exec, 1
    s_mov_b32 s44, 12588032
    v_mov_b32 v1, 0
    v_mov_b32 v2, 1
    s_waitcnt vmcnt(0)
    buffer_atomic_add v2, v1, s[16:19], s44 offen sc1
    s_endpgm
k2_loader:
    s_mul_i32 s40, s36, 167936
    s_add_u32 s40, s40, 2642432
    s_mov_b32 s41, 62464
    v_lshlrev_b32 v1, 4, v0
    s_load_dwordx2 s[6:7], s[0:1], 0
    v_lshlrev_b32 v2, 2, v0
    v_add_u32 v2, 160768, v2
    v_mov_b32 v3, 0
    s_mov_b64 exec, 0xffff
    ds_write_b32 v2, v3
    s_mov_b64 exec, -1
    v_mov_b32 v4, 160768
    v_and_b32 v5, 7, v0
    v_lshl_add_u32 v5, v5, 2, v4
    s_mul_i32 s44, s36, 20
    s_add_u32 s45, s44, 19
    s_lshr_b32 s44, s44, 7
    s_lshr_b32 s45, s45, 7
    s_sub_u32 s45, s45, s44
    v_and_b32 v7, 1, v0
    v_mul_u32_u24 v7, s45, v7
    v_lshrrev_b32 v8, 1, v0
    v_mul_u32_u24 v8, 5, v8
    v_add3_u32 v7, v7, v8, s44
    v_min_u32 v7, 15, v7
    v_mul_u32_u24 v7, 2048, v7
    s_bfe_u32 s44, s2, 0x40003
    s_lshl_b32 s44, s44, 7
    s_add_u32 s44, s44, 12589056
    s_mov_b64 exec, 0x7f
    s_mov_b32 s45, 0
k2_poll:
    v_mov_b32 v8, 0
    buffer_atomic_add v8, v7, s[16:19], s44 offen sc0 sc1
    s_waitcnt vmcnt(0)
    v_cmp_ne_u32 vcc, 16, v8
    s_add_u32 s45, s45, 1
    s_cmp_gt_u32 s45, 0x4000
    s_cbranch_scc1 k2_poll_ok
    s_nop 1
    s_cbranch_vccz k2_poll_ok
    s_branch k2_poll
k2_poll_ok:
    s_mov_b64 exec, -1
    s_barrier
    s_mov_b32 m0, s41
    s_add_u32 s41, s41, 4096
    buffer_load_dwordx4 v1, s[16:19], s40 offen offset:0 sc1 lds
    buffer_load_dwordx4 v1, s[16:19], s40 offen offset:1024 sc1 lds
    buffer_load_dwordx4 v1, s[16:19], s40 offen offset:2048 sc1 lds
    buffer_load_dwordx4 v1, s[16:19], s40 offen offset:3072 sc1 lds
    s_add_u32 s40, s40, 4096
    s_mov_b32 m0, s41
    s_add_u32 s41, s41, 4096
    buffer_load_dwordx4 v1, s[16:19], s40 offen offset:0 sc1 lds
    buffer_load_dwordx4 v1, s[16:19], s40 offen offset:1024 sc1 lds
    buffer_load_dwordx4 v1, s[16:19], s40 offen offset:2048 sc1 lds
    buffer_load_dwordx4 v1, s[16:19], s40 offen offset:3072 sc1 lds
    s_add_u32 s40, s40, 4096
    s_mov_b32 m0, s41
    s_add_u32 s41, s41, 4096
    buffer_load_dwordx4 v1, s[16:19], s40 offen offset:0 sc1 lds
    buffer_load_dwordx4 v1, s[16:19], s40 offen offset:1024 sc1 lds
    buffer_load_dwordx4 v1, s[16:19], s40 offen offset:2048 sc1 lds
    buffer_load_dwordx4 v1, s[16:19], s40 offen offset:3072 sc1 lds
    s_add_u32 s40, s40, 4096
    s_mov_b32 m0, s41
    s_add_u32 s41, s41, 4096
    buffer_load_dwordx4 v1, s[16:19], s40 offen offset:0 sc1 lds
    buffer_load_dwordx4 v1, s[16:19], s40 offen offset:1024 sc1 lds
    buffer_load_dwordx4 v1, s[16:19], s40 offen offset:2048 sc1 lds
    buffer_load_dwordx4 v1, s[16:19], s40 offen offset:3072 sc1 lds
    s_add_u32 s40, s40, 4096
    s_mov_b32 m0, s41
    s_add_u32 s41, s41, 4096
    buffer_load_dwordx4 v1, s[16:19], s40 offen offset:0 sc1 lds
    buffer_load_dwordx4 v1, s[16:19], s40 offen offset:1024 sc1 lds
    buffer_load_dwordx4 v1, s[16:19], s40 offen offset:2048 sc1 lds
    buffer_load_dwordx4 v1, s[16:19], s40 offen offset:3072 sc1 lds
    s_add_u32 s40, s40, 4096
    s_mov_b32 m0, s41
    s_add_u32 s41, s41, 1024
    buffer_load_dwordx4 v1, s[16:19], s40 offen offset:0 sc1 lds
    s_add_u32 s40, s40, 512
    s_waitcnt lgkmcnt(0)
    s_barrier
    s_setprio 3
    s_mov_b32 m0, s41
    s_add_u32 s41, s41, 4096
    buffer_load_dwordx4 v1, s[16:19], s40 offen offset:0 sc1 lds
    buffer_load_dwordx4 v1, s[16:19], s40 offen offset:1024 sc1 lds
    buffer_load_dwordx4 v1, s[16:19], s40 offen offset:2048 sc1 lds
    buffer_load_dwordx4 v1, s[16:19], s40 offen offset:3072 sc1 lds
    s_add_u32 s40, s40, 4096
    s_mov_b32 m0, s41
    s_add_u32 s41, s41, 4096
    buffer_load_dwordx4 v1, s[16:19], s40 offen offset:0 sc1 lds
    buffer_load_dwordx4 v1, s[16:19], s40 offen offset:1024 sc1 lds
    buffer_load_dwordx4 v1, s[16:19], s40 offen offset:2048 sc1 lds
    buffer_load_dwordx4 v1, s[16:19], s40 offen offset:3072 sc1 lds
    s_add_u32 s40, s40, 4096
    s_mov_b32 m0, s41
    s_add_u32 s41, s41, 4096
    buffer_load_dwordx4 v1, s[16:19], s40 offen offset:0 sc1 lds
    buffer_load_dwordx4 v1, s[16:19], s40 offen offset:1024 sc1 lds
    buffer_load_dwordx4 v1, s[16:19], s40 offen offset:2048 sc1 lds
    buffer_load_dwordx4 v1, s[16:19], s40 offen offset:3072 sc1 lds
    s_add_u32 s40, s40, 4096
    s_mov_b32 m0, s41
    s_add_u32 s41, s41, 4096
    buffer_load_dwordx4 v1, s[16:19], s40 offen offset:0 sc1 lds
    buffer_load_dwordx4 v1, s[16:19], s40 offen offset:1024 sc1 lds
    buffer_load_dwordx4 v1, s[16:19], s40 offen offset:2048 sc1 lds
    buffer_load_dwordx4 v1, s[16:19], s40 offen offset:3072 sc1 lds
    s_add_u32 s40, s40, 4096
    s_mov_b32 m0, s41
    s_add_u32 s41, s41, 4096
    buffer_load_dwordx4 v1, s[16:19], s40 offen offset:0 sc1 lds
    buffer_load_dwordx4 v1, s[16:19], s40 offen offset:1024 sc1 lds
    buffer_load_dwordx4 v1, s[16:19], s40 offen offset:2048 sc1 lds
    buffer_load_dwordx4 v1, s[16:19], s40 offen offset:3072 sc1 lds
    s_add_u32 s40, s40, 4096
    s_mov_b32 m0, s41
    s_add_u32 s41, s41, 1024
    buffer_load_dwordx4 v1, s[16:19], s40 offen offset:0 sc1 lds
    s_add_u32 s40, s40, 512
    s_waitcnt vmcnt(21)
    s_barrier
    s_mov_b32 m0, s41
    s_add_u32 s41, s41, 4096
    buffer_load_dwordx4 v1, s[16:19], s40 offen offset:0 sc1 lds
    buffer_load_dwordx4 v1, s[16:19], s40 offen offset:1024 sc1 lds
    buffer_load_dwordx4 v1, s[16:19], s40 offen offset:2048 sc1 lds
    buffer_load_dwordx4 v1, s[16:19], s40 offen offset:3072 sc1 lds
    s_add_u32 s40, s40, 4096
    s_mov_b32 m0, s41
    s_add_u32 s41, s41, 4096
    buffer_load_dwordx4 v1, s[16:19], s40 offen offset:0 sc1 lds
    buffer_load_dwordx4 v1, s[16:19], s40 offen offset:1024 sc1 lds
    buffer_load_dwordx4 v1, s[16:19], s40 offen offset:2048 sc1 lds
    buffer_load_dwordx4 v1, s[16:19], s40 offen offset:3072 sc1 lds
    s_add_u32 s40, s40, 4096
    s_mov_b32 m0, s41
    s_add_u32 s41, s41, 4096
    buffer_load_dwordx4 v1, s[16:19], s40 offen offset:0 sc1 lds
    buffer_load_dwordx4 v1, s[16:19], s40 offen offset:1024 sc1 lds
    buffer_load_dwordx4 v1, s[16:19], s40 offen offset:2048 sc1 lds
    buffer_load_dwordx4 v1, s[16:19], s40 offen offset:3072 sc1 lds
    s_add_u32 s40, s40, 4096
    s_mov_b32 m0, s41
    s_add_u32 s41, s41, 4096
    buffer_load_dwordx4 v1, s[16:19], s40 offen offset:0 sc1 lds
    buffer_load_dwordx4 v1, s[16:19], s40 offen offset:1024 sc1 lds
    buffer_load_dwordx4 v1, s[16:19], s40 offen offset:2048 sc1 lds
    buffer_load_dwordx4 v1, s[16:19], s40 offen offset:3072 sc1 lds
    s_add_u32 s40, s40, 4096
    s_mov_b32 m0, s41
    s_add_u32 s41, s41, 4096
    buffer_load_dwordx4 v1, s[16:19], s40 offen offset:0 sc1 lds
    buffer_load_dwordx4 v1, s[16:19], s40 offen offset:1024 sc1 lds
    buffer_load_dwordx4 v1, s[16:19], s40 offen offset:2048 sc1 lds
    buffer_load_dwordx4 v1, s[16:19], s40 offen offset:3072 sc1 lds
    s_add_u32 s40, s40, 4096
    s_mov_b32 m0, s41
    s_add_u32 s41, s41, 1024
    buffer_load_dwordx4 v1, s[16:19], s40 offen offset:0 sc1 lds
    s_add_u32 s40, s40, 512
    v_mov_b32 v3, 3
    s_waitcnt vmcnt(21)
    ds_write_b32 v4, v3
    v_mov_b32 v3, 4
    s_waitcnt vmcnt(0)
    ds_write_b32 v4, v3
    s_mov_b32 s41, 40960
    s_mov_b32 s42, 1
k2_ld_loop:
    ds_read_b32 v6, v5 offset:32
    s_waitcnt lgkmcnt(0)
    v_cmp_gt_i32 vcc, s42, v6
    s_nop 4
    s_cbranch_vccz k2_ld_free
    s_sleep 5
    s_branch k2_ld_loop
k2_ld_free:
    s_mov_b32 m0, s41
    s_add_u32 s41, s41, 4096
    buffer_load_dwordx4 v1, s[16:19], s40 offen offset:0 sc1 lds
    buffer_load_dwordx4 v1, s[16:19], s40 offen offset:1024 sc1 lds
    buffer_load_dwordx4 v1, s[16:19], s40 offen offset:2048 sc1 lds
    buffer_load_dwordx4 v1, s[16:19], s40 offen offset:3072 sc1 lds
    s_add_u32 s40, s40, 4096
    s_mov_b32 m0, s41
    s_add_u32 s41, s41, 4096
    buffer_load_dwordx4 v1, s[16:19], s40 offen offset:0 sc1 lds
    buffer_load_dwordx4 v1, s[16:19], s40 offen offset:1024 sc1 lds
    buffer_load_dwordx4 v1, s[16:19], s40 offen offset:2048 sc1 lds
    buffer_load_dwordx4 v1, s[16:19], s40 offen offset:3072 sc1 lds
    s_add_u32 s40, s40, 4096
    s_mov_b32 m0, s41
    s_add_u32 s41, s41, 4096
    buffer_load_dwordx4 v1, s[16:19], s40 offen offset:0 sc1 lds
    buffer_load_dwordx4 v1, s[16:19], s40 offen offset:1024 sc1 lds
    buffer_load_dwordx4 v1, s[16:19], s40 offen offset:2048 sc1 lds
    buffer_load_dwordx4 v1, s[16:19], s40 offen offset:3072 sc1 lds
    s_add_u32 s40, s40, 4096
    s_mov_b32 m0, s41
    s_add_u32 s41, s41, 4096
    buffer_load_dwordx4 v1, s[16:19], s40 offen offset:0 sc1 lds
    buffer_load_dwordx4 v1, s[16:19], s40 offen offset:1024 sc1 lds
    buffer_load_dwordx4 v1, s[16:19], s40 offen offset:2048 sc1 lds
    buffer_load_dwordx4 v1, s[16:19], s40 offen offset:3072 sc1 lds
    s_add_u32 s40, s40, 4096
    s_mov_b32 m0, s41
    s_add_u32 s41, s41, 4096
    buffer_load_dwordx4 v1, s[16:19], s40 offen offset:0 sc1 lds
    buffer_load_dwordx4 v1, s[16:19], s40 offen offset:1024 sc1 lds
    buffer_load_dwordx4 v1, s[16:19], s40 offen offset:2048 sc1 lds
    buffer_load_dwordx4 v1, s[16:19], s40 offen offset:3072 sc1 lds
    s_add_u32 s40, s40, 4096
    s_mov_b32 m0, s41
    s_add_u32 s41, s41, 1024
    buffer_load_dwordx4 v1, s[16:19], s40 offen offset:0 sc1 lds
    s_add_u32 s40, s40, 512
    s_add_u32 s42, s42, 1
    s_cmp_lt_u32 s42, 5
    s_cselect_b32 s44, 3, 8
    s_add_u32 s44, s44, s42
    v_mov_b32 v3, s44
    s_waitcnt vmcnt(0)
    ds_write_b32 v4, v3
    s_cmp_lt_u32 s42, 5
    s_cbranch_scc1 k2_ld_loop
    s_waitcnt lgkmcnt(0)
    s_mov_b32 s12, s6
    s_and_b32 s13, s7, 0xffff
    s_mov_b32 s14, 2621440
    s_mov_b32 s15, 0x00020000
    v_lshlrev_b32 v1, 7, v0
    s_lshr_b32 s44, s2, 3
    s_mul_i32 s45, s44, 25600
    s_add_u32 s45, s45, 10620928
    buffer_load_dword v2, v1, s[16:19], s45 offen sc1
    s_add_u32 s45, s45, 8192
    buffer_load_dword v3, v1, s[16:19], s45 offen sc1
    s_add_u32 s45, s45, 8192
    buffer_load_dword v4, v1, s[16:19], s45 offen sc1
    s_add_u32 s45, s45, 8192
    s_mov_b64 exec, 0xff
    buffer_load_dword v5, v1, s[16:19], s45 offen sc1
    s_add_u32 s45, s45, 8192
    s_mov_b64 exec, -1
    s_and_b32 s45, s2, 7
    s_lshl_b32 s45, s45, 5
    s_add_u32 s45, s45, s44
    s_mul_i32 s46, s45, 10240
    buffer_load_dword v6, v1, s[12:15], s46 offen
    s_add_u32 s46, s46, 8192
    s_mov_b64 exec, 0xffff
    buffer_load_dword v7, v1, s[12:15], s46 offen
    s_lshl_b32 s46, s45, 6
    s_add_u32 s46, s46, 12546048
    s_mov_b64 exec, 1
    buffer_load_dword v8, v1, s[16:19], s46 offen
    s_waitcnt vmcnt(0)
    s_branch k3_ywave
p3_tail:
    s_mov_b64 exec, -1
    s_mov_b32 s26, s38
    s_and_b32 s40, s2, 7
    s_lshl_b32 s40, s40, 2
    s_bfe_u32 s41, s2, 0x20003
    s_add_u32 s24, s40, s41
    s_lshr_b32 s25, s2, 5
    s_cmp_lt_u32 s26, 4
    s_cbranch_scc1 k3_compute
    s_cmp_eq_u32 s26, 7
    s_cbranch_scc1 p3_watch
    s_sub_u32 s43, s26, 4
    s_mul_i32 s41, s43, 13312
    s_min_u32 s41, s41, 26624
    s_add_u32 s41, s41, 62464
    s_mul_i32 s40, s25, 102400
    s_add_u32 s40, s40, 10620928
    s_add_u32 s40, s40, s41
    v_lshlrev_b32 v1, 4, v0
    s_waitcnt vmcnt(0)
    s_barrier
    s_mov_b32 m0, s41
    s_add_u32 s41, s41, 4096
    buffer_load_dwordx4 v1, s[16:19], s40 offen offset:0 lds
    buffer_load_dwordx4 v1, s[16:19], s40 offen offset:1024 lds
    buffer_load_dwordx4 v1, s[16:19], s40 offen offset:2048 lds
    buffer_load_dwordx4 v1, s[16:19], s40 offen offset:3072 lds
    s_add_u32 s40, s40, 4096
    s_mov_b32 m0, s41
    s_add_u32 s41, s41, 4096
    buffer_load_dwordx4 v1, s[16:19], s40 offen offset:0 lds
    buffer_load_dwordx4 v1, s[16:19], s40 offen offset:1024 lds
    buffer_load_dwordx4 v1, s[16:19], s40 offen offset:2048 lds
    buffer_load_dwordx4 v1, s[16:19], s40 offen offset:3072 lds
    s_add_u32 s40, s40, 4096
    s_mov_b32 m0, s41
    s_add_u32 s41, s41, 4096
    buffer_load_dwordx4 v1, s[16:19], s40 offen offset:0 lds
    buffer_load_dwordx4 v1, s[16:19], s40 offen offset:1024 lds
    buffer_load_dwordx4 v1, s[16:19], s40 offen offset:2048 lds
    buffer_load_dwordx4 v1, s[16:19], s40 offen offset:3072 lds
    s_add_u32 s40, s40, 4096
    s_mov_b32 m0, s41
    s_add_u32 s41, s41, 4096
    buffer_load_dwordx4 v1, s[16:19], s40 offen offset:0 lds
    s_add_u32 s40, s40, 4096
    s_waitcnt vmcnt(0)
    s_barrier
    s_endpgm
p3_watch:
    s_waitcnt vmcnt(0)
    s_barrier
    v_and_b32 v1, 31, v0
    v_lshlrev_b32 v1, 2, v1
    s_lshr_b32 s44, s24, 2
    s_mul_i32 s44, s44, 4
    s_bfe_u32 s45, s2, 0x20003
    s_add_u32 s44, s44, s45
    s_lshl_b32 s44, s44, 7
    s_add_u32 s44, s44, 12583936
    s_mov_b64 exec, 1
    s_mov_b32 s45, 0
k3_poll:
    v_mov_b32 v4, 0
    buffer_atomic_add v4, v1, s[16:19], s44 offen sc0 sc1
    s_waitcnt vmcnt(0)
    v_cmp_ne_u32 vcc, 32, v4
    s_add_u32 s45, s45, 1
    s_cmp_gt_u32 s45, 0x4000
    s_cbranch_scc1 k3_poll_ok
    s_nop 1
    s_cbranch_vccz k3_poll_ok
    s_sleep 2
    s_branch k3_poll
k3_poll_ok:
k3_seen:
    s_barrier
    s_endpgm
k3_ywave:
    s_mov_b64 exec, -1
    s_mov_b32 s26, 8
    s_and_b32 s40, s2, 7
    s_lshl_b32 s40, s40, 2
    s_bfe_u32 s41, s2, 0x20003
    s_add_u32 s24, s40, s41
    s_lshr_b32 s25, s2, 5
    s_mov_b32 s46, 12588032
    v_mov_b32 v2, 0
    s_mov_b32 s47, 0
k3_e2:
    buffer_load_dword v3, v2, s[16:19], s46 offen sc1
    s_add_u32 s47, s47, 1
    s_waitcnt vmcnt(0)
    v_readfirstlane_b32 s48, v3
    s_cmp_gt_u32 s47, 0x4000
    s_cbranch_scc1 k3_e2_ok
    s_cmp_ge_u32 s48, 268
    s_cbranch_scc1 k3_e2_ok
    s_sleep 8
    s_branch k3_e2
k3_e2_ok:
    s_mul_i32 s40, s25, 102400
    s_add_u32 s40, s40, 10620928
    s_mov_b32 s41, 0
    v_lshlrev_b32 v1, 4, v0
    v_and_b32 v5, 7, v0
    v_lshlrev_b32 v5, 2, v5
    v_add_u32 v5, 160800, v5
    s_mov_b32 m0, s41
    s_add_u32 s41, s41, 4096
    buffer_load_dwordx4 v1, s[16:19], s40 offen offset:0 lds
    buffer_load_dwordx4 v1, s[16:19], s40 offen offset:1024 lds
    buffer_load_dwordx4 v1, s[16:19], s40 offen offset:2048 lds
    buffer_load_dwordx4 v1, s[16:19], s40 offen offset:3072 lds
    s_add_u32 s40, s40, 4096
    s_mov_b32 m0, s41
    s_add_u32 s41, s41, 4096
    buffer_load_dwordx4 v1, s[16:19], s40 offen offset:0 lds
    buffer_load_dwordx4 v1, s[16:19], s40 offen offset:1024 lds
    buffer_load_dwordx4 v1, s[16:19], s40 offen offset:2048 lds
    buffer_load_dwordx4 v1, s[16:19], s40 offen offset:3072 lds
    s_add_u32 s40, s40, 4096
    s_mov_b32 m0, s41
    s_add_u32 s41, s41, 4096
    buffer_load_dwordx4 v1, s[16:19], s40 offen offset:0 lds
    buffer_load_dwordx4 v1, s[16:19], s40 offen offset:1024 lds
    buffer_load_dwordx4 v1, s[16:19], s40 offen offset:2048 lds
    buffer_load_dwordx4 v1, s[16:19], s40 offen offset:3072 lds
    s_add_u32 s40, s40, 4096
    s_mov_b32 m0, s41
    s_add_u32 s41, s41, 4096
    buffer_load_dwordx4 v1, s[16:19], s40 offen offset:0 lds
    buffer_load_dwordx4 v1, s[16:19], s40 offen offset:1024 lds
    buffer_load_dwordx4 v1, s[16:19], s40 offen offset:2048 lds
    buffer_load_dwordx4 v1, s[16:19], s40 offen offset:3072 lds
    s_add_u32 s40, s40, 4096
    s_mov_b32 m0, s41
    s_add_u32 s41, s41, 4096
    buffer_load_dwordx4 v1, s[16:19], s40 offen offset:0 lds
    buffer_load_dwordx4 v1, s[16:19], s40 offen offset:1024 lds
    buffer_load_dwordx4 v1, s[16:19], s40 offen offset:2048 lds
    buffer_load_dwordx4 v1, s[16:19], s40 offen offset:3072 lds
    s_add_u32 s40, s40, 4096
    s_mov_b32 m0, s41
    s_add_u32 s41, s41, 4096
    buffer_load_dwordx4 v1, s[16:19], s40 offen offset:0 lds
    buffer_load_dwordx4 v1, s[16:19], s40 offen offset:1024 lds
    buffer_load_dwordx4 v1, s[16:19], s40 offen offset:2048 lds
    buffer_load_dwordx4 v1, s[16:19], s40 offen offset:3072 lds
    s_add_u32 s40, s40, 4096
    s_mov_b32 m0, s41
    s_add_u32 s41, s41, 4096
    buffer_load_dwordx4 v1, s[16:19], s40 offen offset:0 lds
    buffer_load_dwordx4 v1, s[16:19], s40 offen offset:1024 lds
    buffer_load_dwordx4 v1, s[16:19], s40 offen offset:2048 lds
    buffer_load_dwordx4 v1, s[16:19], s40 offen offset:3072 lds
    s_add_u32 s40, s40, 4096
    s_mov_b32 m0, s41
    s_add_u32 s41, s41, 4096
    buffer_load_dwordx4 v1, s[16:19], s40 offen offset:0 lds
    buffer_load_dwordx4 v1, s[16:19], s40 offen offset:1024 lds
    buffer_load_dwordx4 v1, s[16:19], s40 offen offset:2048 lds
    buffer_load_dwordx4 v1, s[16:19], s40 offen offset:3072 lds
    s_add_u32 s40, s40, 4096
    s_mov_b32 m0, s41
    s_add_u32 s41, s41, 4096
    buffer_load_dwordx4 v1, s[16:19], s40 offen offset:0 lds
    buffer_load_dwordx4 v1, s[16:19], s40 offen offset:1024 lds
    buffer_load_dwordx4 v1, s[16:19], s40 offen offset:2048 lds
    buffer_load_dwordx4 v1, s[16:19], s40 offen offset:3072 lds
    s_add_u32 s40, s40, 4096
    s_mov_b32 m0, s41
    s_add_u32 s41, s41, 4096
    buffer_load_dwordx4 v1, s[16:19], s40 offen offset:0 lds
    buffer_load_dwordx4 v1, s[16:19], s40 offen offset:1024 lds
    buffer_load_dwordx4 v1, s[16:19], s40 offen offset:2048 lds
    buffer_load_dwordx4 v1, s[16:19], s40 offen offset:3072 lds
    s_add_u32 s40, s40, 4096
p3_free5:
    ds_read_b32 v6, v5
    s_waitcnt lgkmcnt(0)
    v_cmp_gt_i32 vcc, 5, v6
    s_nop 4
    s_cbranch_vccz p3_free5_ok
    s_sleep 8
    s_branch p3_free5
p3_free5_ok:
    s_mov_b32 m0, s41
    s_add_u32 s41, s41, 4096
    buffer_load_dwordx4 v1, s[16:19], s40 offen offset:0 lds
    buffer_load_dwordx4 v1, s[16:19], s40 offen offset:1024 lds
    buffer_load_dwordx4 v1, s[16:19], s40 offen offset:2048 lds
    buffer_load_dwordx4 v1, s[16:19], s40 offen offset:3072 lds
    s_add_u32 s40, s40, 4096
    s_mov_b32 m0, s41
    s_add_u32 s41, s41, 4096
    buffer_load_dwordx4 v1, s[16:19], s40 offen offset:0 lds
    buffer_load_dwordx4 v1, s[16:19], s40 offen offset:1024 lds
    buffer_load_dwordx4 v1, s[16:19], s40 offen offset:2048 lds
    buffer_load_dwordx4 v1, s[16:19], s40 offen offset:3072 lds
    s_add_u32 s40, s40, 4096
    s_mov_b32 m0, s41
    s_add_u32 s41, s41, 4096
    buffer_load_dwordx4 v1, s[16:19], s40 offen offset:0 lds
    buffer_load_dwordx4 v1, s[16:19], s40 offen offset:1024 lds
    buffer_load_dwordx4 v1, s[16:19], s40 offen offset:2048 lds
    buffer_load_dwordx4 v1, s[16:19], s40 offen offset:3072 lds
    s_add_u32 s40, s40, 4096
    s_mov_b32 m0, s41
    s_add_u32 s41, s41, 4096
    buffer_load_dwordx4 v1, s[16:19], s40 offen offset:0 lds
    buffer_load_dwordx4 v1, s[16:19], s40 offen offset:1024 lds
    buffer_load_dwordx4 v1, s[16:19], s40 offen offset:2048 lds
    buffer_load_dwordx4 v1, s[16:19], s40 offen offset:3072 lds
    s_add_u32 s40, s40, 4096
    s_mov_b32 m0, s41
    s_add_u32 s41, s41, 4096
    buffer_load_dwordx4 v1, s[16:19], s40 offen offset:0 lds
    buffer_load_dwordx4 v1, s[16:19], s40 offen offset:1024 lds
    buffer_load_dwordx4 v1, s[16:19], s40 offen offset:2048 lds
    buffer_load_dwordx4 v1, s[16:19], s40 offen offset:3072 lds
    s_add_u32 s40, s40, 4096
    s_mov_b32 m0, s41
    s_add_u32 s41, s41, 1024
    buffer_load_dwordx4 v1, s[16:19], s40 offen offset:0 lds
    s_add_u32 s40, s40, 1024
    s_waitcnt lgkmcnt(0)
    s_mov_b32 s16, s4
    s_and_b32 s17, s5, 0xffff
    s_mov_b32 s18, 16777216
    s_mov_b32 s19, 0x00020000
    s_add_u32 s10, s4, 12562944
    s_addc_u32 s11, s5, 0
    s_load_dwordx8 s[28:35], s[10:11], 0
    v_cmp_gt_u32 vcc, 60, v0
    v_mov_b32 v81, 0x40000000
    v_lshlrev_b32 v77, 4, v0
    v_cndmask_b32 v76, v81, v77, vcc
    s_mov_b32 s40, 0
    s_waitcnt lgkmcnt(0)
    s_and_b32 s43, s28, 0x7ff
    s_sub_u32 s43, 2047, s43
    s_lshr_b32 s43, s43, 6
    s_cmp_eq_u32 s43, s24
    s_cselect_b32 s43, 1, 0
    s_or_b32 s40, s40, s43
    s_and_b32 s43, s29, 0x7ff
    s_sub_u32 s43, 2047, s43
    s_lshr_b32 s43, s43, 6
    s_cmp_eq_u32 s43, s24
    s_cselect_b32 s43, 2, 0
    s_or_b32 s40, s40, s43
    s_and_b32 s43, s30, 0x7ff
    s_sub_u32 s43, 2047, s43
    s_lshr_b32 s43, s43, 6
    s_cmp_eq_u32 s43, s24
    s_cselect_b32 s43, 4, 0
    s_or_b32 s40, s40, s43
    s_and_b32 s43, s31, 0x7ff
    s_sub_u32 s43, 2047, s43
    s_lshr_b32 s43, s43, 6
    s_cmp_eq_u32 s43, s24
    s_cselect_b32 s43, 8, 0
    s_or_b32 s40, s40, s43
    s_and_b32 s43, s32, 0x7ff
    s_sub_u32 s43, 2047, s43
    s_lshr_b32 s43, s43, 6
    s_cmp_eq_u32 s43, s24
    s_cselect_b32 s43, 16, 0
    s_or_b32 s40, s40, s43
    s_and_b32 s43, s33, 0x7ff
    s_sub_u32 s43, 2047, s43
    s_lshr_b32 s43, s43, 6
    s_cmp_eq_u32 s43, s24
    s_cselect_b32 s43, 32, 0
    s_or_b32 s40, s40, s43
    s_and_b32 s43, s34, 0x7ff
    s_sub_u32 s43, 2047, s43
    s_lshr_b32 s43, s43, 6
    s_cmp_eq_u32 s43, s24
    s_cselect_b32 s43, 64, 0
    s_or_b32 s40, s40, s43
    s_and_b32 s43, s35, 0x7ff
    s_sub_u32 s43, 2047, s43
    s_lshr_b32 s43, s43, 6
    s_cmp_eq_u32 s43, s24
    s_cselect_b32 s43, 128, 0
    s_or_b32 s40, s40, s43
    s_cmp_eq_u32 s40, 0
    s_cbranch_scc1 p3_noy
    s_ff1_i32_b32 s41, s40
    s_lshl_b32 s42, s41, 3
    s_add_u32 s42, s42, s25
    s_mul_i32 s42, s42, 17280
    s_add_u32 s42, s42, 11440128
    buffer_load_dwordx4 v[4:7], v76, s[16:19], s42 offen offset:0 sc1
    buffer_load_dwordx4 v[8:11], v76, s[16:19], s42 offen offset:960 sc1
    buffer_load_dwordx4 v[12:15], v76, s[16:19], s42 offen offset:1920 sc1
    buffer_load_dwordx4 v[16:19], v76, s[16:19], s42 offen offset:2880 sc1
    s_add_u32 s42, s42, 3840
    buffer_load_dwordx4 v[20:23], v76, s[16:19], s42 offen offset:0 sc1
    buffer_load_dwordx4 v[24:27], v76, s[16:19], s42 offen offset:960 sc1
    buffer_load_dwordx4 v[28:31], v76, s[16:19], s42 offen offset:1920 sc1
    buffer_load_dwordx4 v[32:35], v76, s[16:19], s42 offen offset:2880 sc1
    s_add_u32 s42, s42, 3840
    buffer_load_dwordx4 v[36:39], v76, s[16:19], s42 offen offset:0 sc1
    buffer_load_dwordx4 v[40:43], v76, s[16:19], s42 offen offset:960 sc1
    buffer_load_dwordx4 v[44:47], v76, s[16:19], s42 offen offset:1920 sc1
    buffer_load_dwordx4 v[48:51], v76, s[16:19], s42 offen offset:2880 sc1
    s_add_u32 s42, s42, 3840
    buffer_load_dwordx4 v[52:55], v76, s[16:19], s42 offen offset:0 sc1
    buffer_load_dwordx4 v[56:59], v76, s[16:19], s42 offen offset:960 sc1
    buffer_load_dwordx4 v[60:63], v76, s[16:19], s42 offen offset:1920 sc1
    buffer_load_dwordx4 v[64:67], v76, s[16:19], s42 offen offset:2880 sc1
    s_add_u32 s42, s42, 3840
    buffer_load_dwordx4 v[68:71], v76, s[16:19], s42 offen offset:0 sc1
    buffer_load_dwordx4 v[72:75], v76, s[16:19], s42 offen offset:960 sc1
    s_barrier
    s_barrier
k3_yloop:
    s_mov_b32 m0, s41
    s_bitset0_b32 s40, s41
    s_movrels_b32 s43, s28
    s_and_b32 s43, s43, 0xffff0000
    s_mov_b32 s44, 0xffff0000
    s_cmp_lt_i32 s43, 0
    s_cmov_b32 s44, 0x80000000
    s_xor_b32 s43, s43, s44
    v_mov_b32 v78, 0xbfb8aa3b
    v_mul_f32 v78, s43, v78
    v_exp_f32 v78, v78
    s_mul_i32 s44, s41, 960
    v_add_f32 v78, 1.0, v78
    s_add_u32 s44, s44, 126976
    v_rcp_f32 v78, v78
    v_add_u32 v79, s44, v77
    s_waitcnt vmcnt(16)
    v_pk_add_f32 v[4:5], v[4:5], v[8:9]
    v_pk_add_f32 v[6:7], v[6:7], v[10:11]
    s_waitcnt vmcnt(15)
    v_pk_add_f32 v[4:5], v[4:5], v[12:13]
    v_pk_add_f32 v[6:7], v[6:7], v[14:15]
    s_waitcnt vmcnt(14)
    v_pk_add_f32 v[4:5], v[4:5], v[16:17]
    v_pk_add_f32 v[6:7], v[6:7], v[18:19]
    s_waitcnt vmcnt(13)
    v_pk_add_f32 v[4:5], v[4:5], v[20:21]
    v_pk_add_f32 v[6:7], v[6:7], v[22:23]
    s_waitcnt vmcnt(12)
    v_pk_add_f32 v[4:5], v[4:5], v[24:25]
    v_pk_add_f32 v[6:7], v[6:7], v[26:27]
    s_waitcnt vmcnt(11)
    v_pk_add_f32 v[4:5], v[4:5], v[28:29]
    v_pk_add_f32 v[6:7], v[6:7], v[30:31]
    s_waitcnt vmcnt(10)
    v_pk_add_f32 v[4:5], v[4:5], v[32:33]
    v_pk_add_f32 v[6:7], v[6:7], v[34:35]
    s_waitcnt vmcnt(9)
    v_pk_add_f32 v[4:5], v[4:5], v[36:37]
    v_pk_add_f32 v[6:7], v[6:7], v[38:39]
    s_waitcnt vmcnt(8)
    v_pk_add_f32 v[4:5], v[4:5], v[40:41]
    v_pk_add_f32 v[6:7], v[6:7], v[42:43]
    s_waitcnt vmcnt(7)
    v_pk_add_f32 v[4:5], v[4:5], v[44:45]
    v_pk_add_f32 v[6:7], v[6:7], v[46:47]
    s_waitcnt vmcnt(6)
    v_pk_add_f32 v[4:5], v[4:5], v[48:49]
    v_pk_add_f32 v[6:7], v[6:7], v[50:51]
    s_waitcnt vmcnt(5)
    v_pk_add_f32 v[4:5], v[4:5], v[52:53]
    v_pk_add_f32 v[6:7], v[6:7], v[54:55]
    s_waitcnt vmcnt(4)
    v_pk_add_f32 v[4:5], v[4:5], v[56:57]
    v_pk_add_f32 v[6:7], v[6:7], v[58:59]
    s_waitcnt vmcnt(3)
    v_pk_add_f32 v[4:5], v[4:5], v[60:61]
    v_pk_add_f32 v[6:7], v[6:7], v[62:63]
    s_waitcnt vmcnt(2)
    v_pk_add_f32 v[4:5], v[4:5], v[64:65]
    v_pk_add_f32 v[6:7], v[6:7], v[66:67]
    s_waitcnt vmcnt(1)
    v_pk_add_f32 v[4:5], v[4:5], v[68:69]
    v_pk_add_f32 v[6:7], v[6:7], v[70:71]
    s_waitcnt vmcnt(0)
    v_pk_add_f32 v[4:5], v[4:5], v[72:73]
    v_pk_add_f32 v[6:7], v[6:7], v[74:75]
    v_mul_f32 v4, v4, v78
    v_mul_f32 v5, v5, v78
    v_mul_f32 v6, v6, v78
    v_mul_f32 v7, v7, v78
    s_mov_b32 exec_hi, 0x0fffffff
    ds_write_b128 v79, v[4:7]
    s_mov_b32 exec_hi, -1
    s_cmp_eq_u32 s40, 0
    s_waitcnt lgkmcnt(0)
    s_cbranch_scc1 k3_ydone
    s_ff1_i32_b32 s41, s40
    s_lshl_b32 s42, s41, 3
    s_add_u32 s42, s42, s25
    s_mul_i32 s42, s42, 17280
    s_add_u32 s42, s42, 11440128
    buffer_load_dwordx4 v[4:7], v76, s[16:19], s42 offen offset:0 sc1
    buffer_load_dwordx4 v[8:11], v76, s[16:19], s42 offen offset:960 sc1
    buffer_load_dwordx4 v[12:15], v76, s[16:19], s42 offen offset:1920 sc1
    buffer_load_dwordx4 v[16:19], v76, s[16:19], s42 offen offset:2880 sc1
    s_add_u32 s42, s42, 3840
    buffer_load_dwordx4 v[20:23], v76, s[16:19], s42 offen offset:0 sc1
    buffer_load_dwordx4 v[24:27], v76, s[16:19], s42 offen offset:960 sc1
    buffer_load_dwordx4 v[28:31], v76, s[16:19], s42 offen offset:1920 sc1
    buffer_load_dwordx4 v[32:35], v76, s[16:19], s42 offen offset:2880 sc1
    s_add_u32 s42, s42, 3840
    buffer_load_dwordx4 v[36:39], v76, s[16:19], s42 offen offset:0 sc1
    buffer_load_dwordx4 v[40:43], v76, s[16:19], s42 offen offset:960 sc1
    buffer_load_dwordx4 v[44:47], v76, s[16:19], s42 offen offset:1920 sc1
    buffer_load_dwordx4 v[48:51], v76, s[16:19], s42 offen offset:2880 sc1
    s_add_u32 s42, s42, 3840
    buffer_load_dwordx4 v[52:55], v76, s[16:19], s42 offen offset:0 sc1
    buffer_load_dwordx4 v[56:59], v76, s[16:19], s42 offen offset:960 sc1
    buffer_load_dwordx4 v[60:63], v76, s[16:19], s42 offen offset:1920 sc1
    buffer_load_dwordx4 v[64:67], v76, s[16:19], s42 offen offset:2880 sc1
    s_add_u32 s42, s42, 3840
    buffer_load_dwordx4 v[68:71], v76, s[16:19], s42 offen offset:0 sc1
    buffer_load_dwordx4 v[72:75], v76, s[16:19], s42 offen offset:960 sc1
    s_branch k3_yloop
k3_ydone:
    s_barrier
    s_endpgm
p3_noy:
    s_waitcnt vmcnt(0)
    s_barrier
    s_endpgm
k3_compute:
    v_and_b32 v1, 15, v0
    v_lshrrev_b32 v2, 4, v0
    s_lshl_b32 s40, s24, 6
    s_lshl_b32 s42, s26, 4
    s_add_u32 s40, s40, s42
    s_mul_i32 s42, s40, 1280
    s_mul_i32 s43, s25, 160
    s_add_u32 s52, s42, s43
    s_lshl_b32 s51, s26, 12
    s_add_u32 s51, s51, 134720
    v_add_u32 v3, 0, v0
    v_mul_u32_u24 v165, 6554, v3
    v_lshrrev_b32 v165, 16, v165
    v_mul_u32_u24 v165, 1120, v165
    v_lshl_add_u32 v160, v3, 4, v165
    v_add_u32 v3, 64, v0
    v_mul_u32_u24 v165, 6554, v3
    v_lshrrev_b32 v165, 16, v165
    v_mul_u32_u24 v165, 1120, v165
    v_lshl_add_u32 v161, v3, 4, v165
    v_add_u32 v3, 128, v0
    v_mul_u32_u24 v165, 6554, v3
    v_lshrrev_b32 v165, 16, v165
    v_mul_u32_u24 v165, 1120, v165
    v_lshl_add_u32 v162, v3, 4, v165
    v_lshrrev_b32 v3, 5, v0
    v_lshl_add_u32 v162, v3, 30, v162
    v_lshlrev_b32 v156, 4, v0
    s_lshl_b32 s54, s40, 3
    s_add_u32 s54, s54, 12546048
    s_and_b32 s42, s26, 1
    s_lshl_b32 s42, s42, 4
    v_add_u32 v3, s42, v1
    v_mul_u32_u24 v165, 163840, v2
    v_lshl_add_u32 v159, v3, 3, v165
    v_lshrrev_b32 v165, 1, v2
    v_mul_u32_u24 v165, 81920, v165
    v_lshl_add_u32 v158, v3, 4, v165
    v_and_b32 v165, 1, v2
    v_lshl_add_u32 v158, v165, 9, v158
    s_mul_i32 s42, s24, 2560
    s_lshr_b32 s43, s26, 1
    s_lshl_b32 s53, s43, 8
    s_add_u32 s53, s53, s42
    s_lshl_b32 s43, s43, 10
    s_add_u32 s41, s43, s42
    s_waitcnt lgkmcnt(0)
    s_mov_b32 s12, s6
    s_and_b32 s13, s7, 0xffff
    s_mov_b32 s14, 2621440
    s_mov_b32 s15, 0x00020000
    s_waitcnt vmcnt(0)
    s_barrier
    s_cmp_lg_u32 s26, 0
    s_cbranch_scc1 p3_flagged
    v_lshlrev_b32 v3, 7, v0
    v_mov_b32 v165, 1
    s_mul_i32 s44, s37, 512
    s_add_u32 s44, s44, 12583936
    s_mov_b32 exec_lo, 0xf
    s_mov_b32 exec_hi, 0
    buffer_atomic_add v165, v3, s[16:19], s44 offen sc1
    s_mov_b64 exec, -1
p3_flagged:
    s_add_u32 m0, s51, 0
    s_nop 0
    buffer_load_dwordx4 v160, s[12:15], s52 offen lds
    s_add_u32 m0, s51, 1024
    s_nop 0
    buffer_load_dwordx4 v161, s[12:15], s52 offen lds
    s_add_u32 m0, s51, 2048
    s_nop 0
    buffer_load_dwordx4 v162, s[12:15], s52 offen lds
    s_add_u32 m0, s51, 3072
    s_mov_b64 exec, 0xff
    buffer_load_dwordx4 v156, s[16:19], s54 offen lds
    s_mov_b64 exec, -1
    s_add_u32 s10, s4, 12562944
    s_addc_u32 s11, s5, 0
    s_load_dwordx8 s[28:35], s[10:11], 0
    s_mov_b32 s20, s8
    s_and_b32 s21, s9, 0xffff
    s_mov_b32 s22, 2621440
    s_mov_b32 s23, 0x00020000
    v_add_u32 v157, 51200, v156
    v_mul_u32_u24 v3, 640, v2
    v_add_u32 v3, s51, v3
    v_lshl_add_u32 v163, v1, 3, v3
    v_lshl_add_u32 v164, v1, 1, v3
    v_lshl_add_u32 v165, v2, 5, s51
    s_lshr_b32 s44, s40, 4
    s_mov_b32 s50, 0
    s_waitcnt lgkmcnt(0)
    s_and_b32 s43, s28, 0x7ff
    s_sub_u32 s43, 2047, s43
    s_lshr_b32 s43, s43, 4
    s_cmp_eq_u32 s43, s44
    s_cselect_b32 s43, 1, 0
    s_or_b32 s50, s50, s43
    s_and_b32 s43, s29, 0x7ff
    s_sub_u32 s43, 2047, s43
    s_lshr_b32 s43, s43, 4
    s_cmp_eq_u32 s43, s44
    s_cselect_b32 s43, 2, 0
    s_or_b32 s50, s50, s43
    s_and_b32 s43, s30, 0x7ff
    s_sub_u32 s43, 2047, s43
    s_lshr_b32 s43, s43, 4
    s_cmp_eq_u32 s43, s44
    s_cselect_b32 s43, 4, 0
    s_or_b32 s50, s50, s43
    s_and_b32 s43, s31, 0x7ff
    s_sub_u32 s43, 2047, s43
    s_lshr_b32 s43, s43, 4
    s_cmp_eq_u32 s43, s44
    s_cselect_b32 s43, 8, 0
    s_or_b32 s50, s50, s43
    s_and_b32 s43, s32, 0x7ff
    s_sub_u32 s43, 2047, s43
    s_lshr_b32 s43, s43, 4
    s_cmp_eq_u32 s43, s44
    s_cselect_b32 s43, 16, 0
    s_or_b32 s50, s50, s43
    s_and_b32 s43, s33, 0x7ff
    s_sub_u32 s43, 2047, s43
    s_lshr_b32 s43, s43, 4
    s_cmp_eq_u32 s43, s44
    s_cselect_b32 s43, 32, 0
    s_or_b32 s50, s50, s43
    s_and_b32 s43, s34, 0x7ff
    s_sub_u32 s43, 2047, s43
    s_lshr_b32 s43, s43, 4
    s_cmp_eq_u32 s43, s44
    s_cselect_b32 s43, 64, 0
    s_or_b32 s50, s50, s43
    s_and_b32 s43, s35, 0x7ff
    s_sub_u32 s43, 2047, s43
    s_lshr_b32 s43, s43, 4
    s_cmp_eq_u32 s43, s44
    s_cselect_b32 s43, 128, 0
    s_or_b32 s50, s50, s43
    s_waitcnt vmcnt(0)
    ds_read_b128 v[116:119], v165 offset:3072
    ds_read_b128 v[120:123], v165 offset:3088
    ds_read_b64 v[96:97], v163 offset:0
    ds_read_u16 v132, v164 offset:128
    ds_read_b64 v[98:99], v163 offset:160
    ds_read_u16 v133, v164 offset:288
    ds_read_b64 v[100:101], v163 offset:320
    ds_read_u16 v134, v164 offset:448
    ds_read_b64 v[102:103], v163 offset:480
    ds_read_u16 v135, v164 offset:608
    s_waitcnt lgkmcnt(8)
    v_add_f32 v124, 1.0, v117
    v_mul_f32 v128, v116, v117
    v_add_f32 v125, 1.0, v119
    v_mul_f32 v129, v118, v119
    v_add_f32 v126, 1.0, v121
    v_mul_f32 v130, v120, v121
    v_add_f32 v127, 1.0, v123
    v_mul_f32 v131, v122, v123
    s_waitcnt lgkmcnt(6)
    v_lshlrev_b32 v136, 16, v96
    v_and_b32 v140, 0xffff0000, v96
    v_lshlrev_b32 v144, 16, v97
    v_and_b32 v148, 0xffff0000, v97
    v_lshlrev_b32 v152, 16, v132
    v_fma_f32 v136, v136, v124, v128
    v_fma_f32 v140, v140, v124, v128
    v_fma_f32 v144, v144, v124, v128
    v_fma_f32 v148, v148, v124, v128
    v_fma_f32 v152, v152, v124, v128
    s_waitcnt lgkmcnt(4)
    v_lshlrev_b32 v137, 16, v98
    v_and_b32 v141, 0xffff0000, v98
    v_lshlrev_b32 v145, 16, v99
    v_and_b32 v149, 0xffff0000, v99
    v_lshlrev_b32 v153, 16, v133
    v_fma_f32 v137, v137, v125, v129
    v_fma_f32 v141, v141, v125, v129
    v_fma_f32 v145, v145, v125, v129
    v_fma_f32 v149, v149, v125, v129
    v_fma_f32 v153, v153, v125, v129
    s_waitcnt lgkmcnt(2)
    v_lshlrev_b32 v138, 16, v100
    v_and_b32 v142, 0xffff0000, v100
    v_lshlrev_b32 v146, 16, v101
    v_and_b32 v150, 0xffff0000, v101
    v_lshlrev_b32 v154, 16, v134
    v_fma_f32 v138, v138, v126, v130
    v_fma_f32 v142, v142, v126, v130
    v_fma_f32 v146, v146, v126, v130
    v_fma_f32 v150, v150, v126, v130
    v_fma_f32 v154, v154, v126, v130
    s_waitcnt lgkmcnt(0)
    v_lshlrev_b32 v139, 16, v102
    v_and_b32 v143, 0xffff0000, v102
    v_lshlrev_b32 v147, 16, v103
    v_and_b32 v151, 0xffff0000, v103
    v_lshlrev_b32 v155, 16, v135
    v_fma_f32 v139, v139, v127, v131
    v_fma_f32 v143, v143, v127, v131
    v_fma_f32 v147, v147, v127, v131
    v_fma_f32 v151, v151, v127, v131
    v_fma_f32 v155, v155, v127, v131
    s_barrier
    buffer_load_dwordx4 v[4:7], v158, s[16:19], s41 offen sc1
    s_add_u32 s41, s41, 163840
    buffer_load_dwordx4 v[8:11], v158, s[16:19], s41 offen sc1
    s_add_u32 s41, s41, 163840
    buffer_load_dwordx4 v[12:15], v158, s[16:19], s41 offen sc1
    s_add_u32 s41, s41, 163840
    buffer_load_dwordx4 v[16:19], v158, s[16:19], s41 offen sc1
    s_add_u32 s41, s41, 163840
    buffer_load_dwordx4 v[20:23], v158, s[16:19], s41 offen sc1
    s_add_u32 s41, s41, 163840
    buffer_load_dwordx4 v[24:27], v158, s[16:19], s41 offen sc1
    s_add_u32 s41, s41, 163840
    s_cmp_eq_u32 s50, 0
    s_cbranch_scc1 k3_ynone
k3_yadd:
    s_ff1_i32_b32 s45, s50
    s_mov_b32 m0, s45
    s_bitset0_b32 s50, s45
    s_movrels_b32 s46, s28
    s_and_b32 s46, s46, 0x7ff
    s_sub_u32 s46, 2047, s46
    s_mul_i32 s47, s45, 960
    s_add_u32 s47, s47, 126976
    v_lshl_add_u32 v3, v1, 4, s47
    v_lshl_add_u32 v165, v1, 2, s47
    ds_read_b128 v[116:119], v3 offset:0
    ds_read_b32 v128, v165 offset:256
    ds_read_b128 v[120:123], v3 offset:320
    ds_read_b32 v129, v165 offset:576
    ds_read_b128 v[124:127], v3 offset:640
    ds_read_b32 v130, v165 offset:896
    s_bfe_u32 s47, s46, 0x20002
    s_lshl_b32 s47, s47, 4
    s_mov_b64 s[48:49], 0xffff
    s_lshl_b64 s[48:49], s[48:49], s47
    s_and_b32 s46, s46, 3
    s_waitcnt lgkmcnt(0)
    v_add_f32 v116, v116, v120
    v_add_f32 v116, v116, v124
    v_add_f32 v117, v117, v121
    v_add_f32 v117, v117, v125
    v_add_f32 v118, v118, v122
    v_add_f32 v118, v118, v126
    v_add_f32 v119, v119, v123
    v_add_f32 v119, v119, v127
    v_add_f32 v128, v128, v129
    v_add_f32 v128, v128, v130
    s_mov_b64 exec, s[48:49]
    s_cmp_lg_u32 s46, 0
    s_cbranch_scc1 k3_yr0
    v_add_f32 v136, v136, v116
    v_add_f32 v140, v140, v117
    v_add_f32 v144, v144, v118
    v_add_f32 v148, v148, v119
    v_add_f32 v152, v152, v128
k3_yr0:
    s_cmp_lg_u32 s46, 1
    s_cbranch_scc1 k3_yr1
    v_add_f32 v137, v137, v116
    v_add_f32 v141, v141, v117
    v_add_f32 v145, v145, v118
    v_add_f32 v149, v149, v119
    v_add_f32 v153, v153, v128
k3_yr1:
    s_cmp_lg_u32 s46, 2
    s_cbranch_scc1 k3_yr2
    v_add_f32 v138, v138, v116
    v_add_f32 v142, v142, v117
    v_add_f32 v146, v146, v118
    v_add_f32 v150, v150, v119
    v_add_f32 v154, v154, v128
k3_yr2:
    s_cmp_lg_u32 s46, 3
    s_cbranch_scc1 k3_yr3
    v_add_f32 v139, v139, v116
    v_add_f32 v143, v143, v117
    v_add_f32 v147, v147, v118
    v_add_f32 v151, v151, v119
    v_add_f32 v155, v155, v128
k3_yr3:
    s_mov_b64 exec, -1
    s_cmp_lg_u32 s50, 0
    s_cbranch_scc1 k3_yadd
    s_nop 0
k3_ynone:
    ds_read_b128 v[76:79], v156 offset:0
    ds_read_b128 v[80:83], v156 offset:1024
    ds_read_b128 v[84:87], v156 offset:2048
    ds_read_b128 v[88:91], v156 offset:3072
    ds_read_b128 v[92:95], v156 offset:4096
    ds_read_b128 v[96:99], v156 offset:5120
    ds_read_b128 v[100:103], v156 offset:6144
    ds_read_b128 v[104:107], v156 offset:7168
    ds_read_b128 v[108:111], v156 offset:8192
    ds_read_b128 v[112:115], v156 offset:9216
    s_waitcnt vmcnt(5) lgkmcnt(5)
    v_mfma_f32_16x16x32_bf16 v[136:139], v[4:7], v[76:79], v[136:139]
    ds_read_b128 v[116:119], v156 offset:10240
    v_mfma_f32_16x16x32_bf16 v[140:143], v[4:7], v[80:83], v[140:143]
    ds_read_b128 v[120:123], v156 offset:11264
    buffer_load_dwordx4 v[28:31], v158, s[16:19], s41 offen sc1
    s_add_u32 s41, s41, 163840
    v_mfma_f32_16x16x32_bf16 v[144:147], v[4:7], v[84:87], v[144:147]
    ds_read_b128 v[124:127], v156 offset:12288
    v_mfma_f32_16x16x32_bf16 v[148:151], v[4:7], v[88:91], v[148:151]
    ds_read_b128 v[128:131], v156 offset:13312
    buffer_load_dwordx4 v[32:35], v158, s[16:19], s41 offen sc1
    s_add_u32 s41, s41, 163840
    v_mfma_f32_16x16x32_bf16 v[152:155], v[4:7], v[92:95], v[152:155]
    s_waitcnt vmcnt(6) lgkmcnt(4)
    ds_read_b128 v[132:135], v156 offset:14336
    v_mfma_f32_16x16x32_bf16 v[136:139], v[8:11], v[96:99], v[136:139]
    ds_read_b128 v[76:79], v156 offset:15360
    v_mfma_f32_16x16x32_bf16 v[140:143], v[8:11], v[100:103], v[140:143]
    ds_read_b128 v[80:83], v156 offset:16384
    buffer_load_dwordx4 v[36:39], v158, s[16:19], s41 offen sc1
    s_add_u32 s41, s41, 163840
    v_mfma_f32_16x16x32_bf16 v[144:147], v[8:11], v[104:107], v[144:147]
    ds_read_b128 v[84:87], v156 offset:17408
    v_mfma_f32_16x16x32_bf16 v[148:151], v[8:11], v[108:111], v[148:151]
    ds_read_b128 v[88:91], v156 offset:18432
    buffer_load_dwordx4 v[40:43], v158, s[16:19], s41 offen sc1
    s_add_u32 s41, s41, 163840
    v_mfma_f32_16x16x32_bf16 v[152:155], v[8:11], v[112:115], v[152:155]
    s_waitcnt vmcnt(7) lgkmcnt(4)
    ds_read_b128 v[92:95], v156 offset:19456
    v_mfma_f32_16x16x32_bf16 v[136:139], v[12:15], v[116:119], v[136:139]
    ds_read_b128 v[96:99], v156 offset:20480
    v_mfma_f32_16x16x32_bf16 v[140:143], v[12:15], v[120:123], v[140:143]
    ds_read_b128 v[100:103], v156 offset:21504
    buffer_load_dwordx4 v[44:47], v158, s[16:19], s41 offen sc1
    s_add_u32 s41, s41, 163840
    v_mfma_f32_16x16x32_bf16 v[144:147], v[12:15], v[124:127], v[144:147]
    ds_read_b128 v[104:107], v156 offset:22528
    v_mfma_f32_16x16x32_bf16 v[148:151], v[12:15], v[128:131], v[148:151]
    ds_read_b128 v[108:111], v156 offset:23552
    buffer_load_dwordx4 v[48:51], v158, s[16:19], s41 offen sc1
    s_add_u32 s41, s41, 163840
    v_mfma_f32_16x16x32_bf16 v[152:155], v[12:15], v[132:135], v[152:155]
    s_waitcnt vmcnt(8) lgkmcnt(4)
    ds_read_b128 v[112:115], v156 offset:24576
    v_mfma_f32_16x16x32_bf16 v[136:139], v[16:19], v[76:79], v[136:139]
    ds_read_b128 v[116:119], v156 offset:25600
    v_mfma_f32_16x16x32_bf16 v[140:143], v[16:19], v[80:83], v[140:143]
    ds_read_b128 v[120:123], v156 offset:26624
    buffer_load_dwordx4 v[52:55], v158, s[16:19], s41 offen sc1
    s_add_u32 s41, s41, 163840
    v_mfma_f32_16x16x32_bf16 v[144:147], v[16:19], v[84:87], v[144:147]
    ds_read_b128 v[124:127], v156 offset:27648
    v_mfma_f32_16x16x32_bf16 v[148:151], v[16:19], v[88:91], v[148:151]
    ds_read_b128 v[128:131], v156 offset:28672
    buffer_load_dwordx4 v[56:59], v158, s[16:19], s41 offen sc1
    s_add_u32 s41, s41, 163840
    v_mfma_f32_16x16x32_bf16 v[152:155], v[16:19], v[92:95], v[152:155]
    s_waitcnt vmcnt(9) lgkmcnt(4)
    ds_read_b128 v[132:135], v156 offset:29696
    v_mfma_f32_16x16x32_bf16 v[136:139], v[20:23], v[96:99], v[136:139]
    ds_read_b128 v[76:79], v156 offset:30720
    v_mfma_f32_16x16x32_bf16 v[140:143], v[20:23], v[100:103], v[140:143]
    ds_read_b128 v[80:83], v156 offset:31744
    buffer_load_dwordx4 v[60:63], v158, s[16:19], s41 offen sc1
    s_add_u32 s41, s41, 163840
    v_mfma_f32_16x16x32_bf16 v[144:147], v[20:23], v[104:107], v[144:147]
    ds_read_b128 v[84:87], v156 offset:32768
    v_mfma_f32_16x16x32_bf16 v[148:151], v[20:23], v[108:111], v[148:151]
    ds_read_b128 v[88:91], v156 offset:33792
    buffer_load_dwordx4 v[64:67], v158, s[16:19], s41 offen sc1
    s_add_u32 s41, s41, 163840
    v_mfma_f32_16x16x32_bf16 v[152:155], v[20:23], v[112:115], v[152:155]
    s_waitcnt vmcnt(10) lgkmcnt(4)
    ds_read_b128 v[92:95], v156 offset:34816
    v_mfma_f32_16x16x32_bf16 v[136:139], v[24:27], v[116:119], v[136:139]
    ds_read_b128 v[96:99], v156 offset:35840
    v_mfma_f32_16x16x32_bf16 v[140:143], v[24:27], v[120:123], v[140:143]
    ds_read_b128 v[100:103], v156 offset:36864
    buffer_load_dwordx2 v[68:69], v159, s[16:19], s53 offen offset:2048 sc1
    s_add_u32 s53, s53, 81920
    buffer_load_dwordx2 v[70:71], v159, s[16:19], s53 offen offset:2048 sc1
    s_add_u32 s53, s53, 573440
    v_mfma_f32_16x16x32_bf16 v[144:147], v[24:27], v[124:127], v[144:147]
    ds_read_b128 v[104:107], v156 offset:37888
    v_mfma_f32_16x16x32_bf16 v[148:151], v[24:27], v[128:131], v[148:151]
    ds_read_b128 v[108:111], v156 offset:38912
    buffer_load_dwordx2 v[72:73], v159, s[16:19], s53 offen offset:2048 sc1
    s_add_u32 s53, s53, 81920
    buffer_load_dwordx2 v[74:75], v159, s[16:19], s53 offen offset:2048 sc1
    s_add_u32 s53, s53, 573440
    v_mfma_f32_16x16x32_bf16 v[152:155], v[24:27], v[132:135], v[152:155]
    s_waitcnt vmcnt(13) lgkmcnt(4)
    ds_read_b128 v[112:115], v156 offset:39936
    v_mfma_f32_16x16x32_bf16 v[136:139], v[28:31], v[76:79], v[136:139]
    ds_read_b128 v[116:119], v156 offset:40960
    v_mfma_f32_16x16x32_bf16 v[140:143], v[28:31], v[80:83], v[140:143]
    ds_read_b128 v[120:123], v156 offset:41984
    buffer_load_dwordx2 v[4:5], v159, s[16:19], s53 offen offset:2048 sc1
    s_add_u32 s53, s53, 81920
    buffer_load_dwordx2 v[6:7], v159, s[16:19], s53 offen offset:2048 sc1
    s_add_u32 s53, s53, 573440
    v_mfma_f32_16x16x32_bf16 v[144:147], v[28:31], v[84:87], v[144:147]
    ds_read_b128 v[124:127], v156 offset:43008
    v_mfma_f32_16x16x32_bf16 v[148:151], v[28:31], v[88:91], v[148:151]
    ds_read_b128 v[128:131], v156 offset:44032
    buffer_load_dwordx2 v[8:9], v159, s[16:19], s53 offen offset:2048 sc1
    s_add_u32 s53, s53, 81920
    buffer_load_dwordx2 v[10:11], v159, s[16:19], s53 offen offset:2048 sc1
    s_add_u32 s53, s53, 573440
    v_mfma_f32_16x16x32_bf16 v[152:155], v[28:31], v[92:95], v[152:155]
    s_waitcnt vmcnt(16) lgkmcnt(4)
    ds_read_b128 v[132:135], v156 offset:45056
    v_mfma_f32_16x16x32_bf16 v[136:139], v[32:35], v[96:99], v[136:139]
    ds_read_b128 v[76:79], v156 offset:46080
    v_mfma_f32_16x16x32_bf16 v[140:143], v[32:35], v[100:103], v[140:143]
    ds_read_b128 v[80:83], v156 offset:47104
    v_mfma_f32_16x16x32_bf16 v[144:147], v[32:35], v[104:107], v[144:147]
    ds_read_b128 v[84:87], v156 offset:48128
    v_mfma_f32_16x16x32_bf16 v[148:151], v[32:35], v[108:111], v[148:151]
    ds_read_b128 v[88:91], v156 offset:49152
    v_mfma_f32_16x16x32_bf16 v[152:155], v[32:35], v[112:115], v[152:155]
    s_waitcnt vmcnt(15) lgkmcnt(4)
    ds_read_b128 v[92:95], v156 offset:50176
    v_mfma_f32_16x16x32_bf16 v[136:139], v[36:39], v[116:119], v[136:139]
    ds_read_b128 v[96:99], v157 offset:0
    v_mfma_f32_16x16x32_bf16 v[140:143], v[36:39], v[120:123], v[140:143]
    ds_read_b128 v[100:103], v157 offset:1024
    v_mfma_f32_16x16x32_bf16 v[144:147], v[36:39], v[124:127], v[144:147]
    ds_read_b128 v[104:107], v157 offset:2048
    v_mfma_f32_16x16x32_bf16 v[148:151], v[36:39], v[128:131], v[148:151]
    ds_read_b128 v[108:111], v157 offset:3072
    v_mfma_f32_16x16x32_bf16 v[152:155], v[36:39], v[132:135], v[152:155]
    s_waitcnt vmcnt(14) lgkmcnt(4)
    ds_read_b128 v[112:115], v157 offset:4096
    v_mfma_f32_16x16x32_bf16 v[136:139], v[40:43], v[76:79], v[136:139]
    ds_read_b128 v[116:119], v157 offset:5120
    v_mfma_f32_16x16x32_bf16 v[140:143], v[40:43], v[80:83], v[140:143]
    ds_read_b128 v[120:123], v157 offset:6144
    v_mfma_f32_16x16x32_bf16 v[144:147], v[40:43], v[84:87], v[144:147]
    ds_read_b128 v[124:127], v157 offset:7168
    v_mfma_f32_16x16x32_bf16 v[148:151], v[40:43], v[88:91], v[148:151]
    ds_read_b128 v[128:131], v157 offset:8192
    v_mfma_f32_16x16x32_bf16 v[152:155], v[40:43], v[92:95], v[152:155]
    s_waitcnt vmcnt(13) lgkmcnt(4)
    ds_read_b128 v[132:135], v157 offset:9216
    v_mfma_f32_16x16x32_bf16 v[136:139], v[44:47], v[96:99], v[136:139]
    ds_read_b128 v[76:79], v157 offset:10240
    v_mfma_f32_16x16x32_bf16 v[140:143], v[44:47], v[100:103], v[140:143]
    ds_read_b128 v[80:83], v157 offset:11264
    v_mfma_f32_16x16x32_bf16 v[144:147], v[44:47], v[104:107], v[144:147]
    ds_read_b128 v[84:87], v157 offset:12288
    v_mfma_f32_16x16x32_bf16 v[148:151], v[44:47], v[108:111], v[148:151]
    ds_read_b128 v[88:91], v157 offset:13312
    v_mfma_f32_16x16x32_bf16 v[152:155], v[44:47], v[112:115], v[152:155]
    s_waitcnt vmcnt(12) lgkmcnt(4)
    ds_read_b128 v[92:95], v157 offset:14336
    v_mfma_f32_16x16x32_bf16 v[136:139], v[48:51], v[116:119], v[136:139]
    ds_read_b128 v[96:99], v157 offset:15360
    v_mfma_f32_16x16x32_bf16 v[140:143], v[48:51], v[120:123], v[140:143]
    ds_read_b128 v[100:103], v157 offset:16384
    v_mfma_f32_16x16x32_bf16 v[144:147], v[48:51], v[124:127], v[144:147]
    ds_read_b128 v[104:107], v157 offset:17408
    v_mfma_f32_16x16x32_bf16 v[148:151], v[48:51], v[128:131], v[148:151]
    ds_read_b128 v[108:111], v157 offset:18432
    v_mfma_f32_16x16x32_bf16 v[152:155], v[48:51], v[132:135], v[152:155]
    s_waitcnt vmcnt(11) lgkmcnt(4)
    ds_read_b128 v[112:115], v157 offset:19456
    v_mfma_f32_16x16x32_bf16 v[136:139], v[52:55], v[76:79], v[136:139]
    ds_read_b128 v[116:119], v157 offset:20480
    v_mfma_f32_16x16x32_bf16 v[140:143], v[52:55], v[80:83], v[140:143]
    ds_read_b128 v[120:123], v157 offset:21504
    v_mfma_f32_16x16x32_bf16 v[144:147], v[52:55], v[84:87], v[144:147]
    ds_read_b128 v[124:127], v157 offset:22528
    v_mfma_f32_16x16x32_bf16 v[148:151], v[52:55], v[88:91], v[148:151]
    ds_read_b128 v[128:131], v157 offset:23552
    v_mfma_f32_16x16x32_bf16 v[152:155], v[52:55], v[92:95], v[152:155]
    s_waitcnt vmcnt(10) lgkmcnt(4)
    ds_read_b128 v[132:135], v157 offset:24576
    v_mfma_f32_16x16x32_bf16 v[136:139], v[56:59], v[96:99], v[136:139]
    ds_read_b128 v[76:79], v157 offset:25600
    v_mfma_f32_16x16x32_bf16 v[140:143], v[56:59], v[100:103], v[140:143]
    ds_read_b128 v[80:83], v157 offset:26624
    v_mfma_f32_16x16x32_bf16 v[144:147], v[56:59], v[104:107], v[144:147]
    ds_read_b128 v[84:87], v157 offset:27648
    v_mfma_f32_16x16x32_bf16 v[148:151], v[56:59], v[108:111], v[148:151]
    ds_read_b128 v[88:91], v157 offset:28672
    v_mfma_f32_16x16x32_bf16 v[152:155], v[56:59], v[112:115], v[152:155]
    s_waitcnt vmcnt(9) lgkmcnt(4)
    ds_read_b128 v[92:95], v157 offset:29696
    v_mfma_f32_16x16x32_bf16 v[136:139], v[60:63], v[116:119], v[136:139]
    ds_read_b128 v[96:99], v157 offset:30720
    v_mfma_f32_16x16x32_bf16 v[140:143], v[60:63], v[120:123], v[140:143]
    ds_read_b128 v[100:103], v157 offset:31744
    v_mfma_f32_16x16x32_bf16 v[144:147], v[60:63], v[124:127], v[144:147]
    ds_read_b128 v[104:107], v157 offset:32768
    v_mfma_f32_16x16x32_bf16 v[148:151], v[60:63], v[128:131], v[148:151]
    ds_read_b128 v[108:111], v157 offset:33792
    v_mfma_f32_16x16x32_bf16 v[152:155], v[60:63], v[132:135], v[152:155]
    s_waitcnt vmcnt(8) lgkmcnt(4)
    ds_read_b128 v[112:115], v157 offset:34816
    v_mfma_f32_16x16x32_bf16 v[136:139], v[64:67], v[76:79], v[136:139]
    ds_read_b128 v[116:119], v157 offset:35840
    v_mfma_f32_16x16x32_bf16 v[140:143], v[64:67], v[80:83], v[140:143]
    ds_read_b128 v[120:123], v157 offset:36864
    v_mfma_f32_16x16x32_bf16 v[144:147], v[64:67], v[84:87], v[144:147]
    ds_read_b128 v[124:127], v157 offset:37888
    v_mfma_f32_16x16x32_bf16 v[148:151], v[64:67], v[88:91], v[148:151]
    ds_read_b128 v[128:131], v157 offset:38912
    v_mfma_f32_16x16x32_bf16 v[152:155], v[64:67], v[92:95], v[152:155]
    s_waitcnt vmcnt(6) lgkmcnt(4)
    ds_read_b128 v[132:135], v157 offset:39936
    v_mfma_f32_16x16x32_bf16 v[136:139], v[68:71], v[96:99], v[136:139]
    ds_read_b128 v[76:79], v157 offset:40960
    v_mfma_f32_16x16x32_bf16 v[140:143], v[68:71], v[100:103], v[140:143]
    ds_read_b128 v[80:83], v157 offset:41984
    v_mfma_f32_16x16x32_bf16 v[144:147], v[68:71], v[104:107], v[144:147]
    ds_read_b128 v[84:87], v157 offset:43008
    v_mfma_f32_16x16x32_bf16 v[148:151], v[68:71], v[108:111], v[148:151]
    ds_read_b128 v[88:91], v157 offset:44032
    v_mfma_f32_16x16x32_bf16 v[152:155], v[68:71], v[112:115], v[152:155]
    s_waitcnt vmcnt(4) lgkmcnt(4)
    ds_read_b128 v[92:95], v157 offset:45056
    v_mfma_f32_16x16x32_bf16 v[136:139], v[72:75], v[116:119], v[136:139]
    ds_read_b128 v[96:99], v157 offset:46080
    v_mfma_f32_16x16x32_bf16 v[140:143], v[72:75], v[120:123], v[140:143]
    ds_read_b128 v[100:103], v157 offset:47104
    v_mfma_f32_16x16x32_bf16 v[144:147], v[72:75], v[124:127], v[144:147]
    ds_read_b128 v[104:107], v157 offset:48128
    v_mfma_f32_16x16x32_bf16 v[148:151], v[72:75], v[128:131], v[148:151]
    ds_read_b128 v[108:111], v157 offset:49152
    v_mfma_f32_16x16x32_bf16 v[152:155], v[72:75], v[132:135], v[152:155]
    s_waitcnt vmcnt(2) lgkmcnt(4)
    ds_read_b128 v[112:115], v157 offset:50176
    v_mfma_f32_16x16x32_bf16 v[136:139], v[4:7], v[76:79], v[136:139]
    v_mfma_f32_16x16x32_bf16 v[140:143], v[4:7], v[80:83], v[140:143]
    v_mfma_f32_16x16x32_bf16 v[144:147], v[4:7], v[84:87], v[144:147]
    v_mfma_f32_16x16x32_bf16 v[148:151], v[4:7], v[88:91], v[148:151]
    v_mfma_f32_16x16x32_bf16 v[152:155], v[4:7], v[92:95], v[152:155]
    s_waitcnt vmcnt(0) lgkmcnt(0)
    v_mfma_f32_16x16x32_bf16 v[136:139], v[8:11], v[96:99], v[136:139]
    v_mfma_f32_16x16x32_bf16 v[140:143], v[8:11], v[100:103], v[140:143]
    v_mfma_f32_16x16x32_bf16 v[144:147], v[8:11], v[104:107], v[144:147]
    v_mfma_f32_16x16x32_bf16 v[148:151], v[8:11], v[108:111], v[148:151]
    v_mfma_f32_16x16x32_bf16 v[152:155], v[8:11], v[112:115], v[152:155]
    v_add_u32 v3, s51, v156
    s_nop 4
    v_cvt_pk_bf16_f32 v36, v136, v140
    v_cvt_pk_bf16_f32 v37, v144, v148
    v_cvt_pk_bf16_f32 v44, v152, v152
    v_cvt_pk_bf16_f32 v38, v137, v141
    v_cvt_pk_bf16_f32 v39, v145, v149
    v_cvt_pk_bf16_f32 v45, v153, v153
    v_cvt_pk_bf16_f32 v40, v138, v142
    v_cvt_pk_bf16_f32 v41, v146, v150
    v_cvt_pk_bf16_f32 v46, v154, v154
    v_cvt_pk_bf16_f32 v42, v139, v143
    v_cvt_pk_bf16_f32 v43, v147, v151
    v_cvt_pk_bf16_f32 v47, v155, v155
    ds_write_b64 v163, v[36:37] offset:0
    ds_write_b16 v164, v44 offset:128
    ds_write_b64 v163, v[38:39] offset:160
    ds_write_b16 v164, v45 offset:288
    ds_write_b64 v163, v[40:41] offset:320
    ds_write_b16 v164, v46 offset:448
    ds_write_b64 v163, v[42:43] offset:480
    ds_write_b16 v164, v47 offset:608
    s_waitcnt lgkmcnt(0)
    ds_read_b128 v[52:55], v3 offset:0
    ds_read_b128 v[56:59], v3 offset:1024
    ds_read_b128 v[60:63], v3 offset:2048
    s_waitcnt lgkmcnt(2)
    buffer_store_dwordx4 v[52:55], v160, s[20:23], s52 offen sc1
    s_waitcnt lgkmcnt(1)
    buffer_store_dwordx4 v[56:59], v161, s[20:23], s52 offen sc1
    s_waitcnt lgkmcnt(0)
    buffer_store_dwordx4 v[60:63], v162, s[20:23], s52 offen sc1
k3_end:
    s_endpgm
.section .rodata,"a"
.p2align 6
.amdhsa_kernel parallel_sum__softmax_full_mha__moe_arch_mod__prompt_kernel
  .amdhsa_next_free_vgpr 168
  .amdhsa_next_free_sgpr 96
  .amdhsa_accum_offset 168
  .amdhsa_group_segment_fixed_size 0
  .amdhsa_kernarg_size 88
  .amdhsa_user_sgpr_count 2
  .amdhsa_user_sgpr_kernarg_segment_ptr 1
  .amdhsa_system_sgpr_workgroup_id_x 1
.end_amdhsa_kernel
```
